```python
import torch

def _softmax(x, axis=-1):
    return torch.softmax(x, dim=axis)
def _gelu(x):
    return torch.nn.functional.gelu(x, approximate="tanh")
def _silu(x):
    return torch.nn.functional.silu(x)
def _sigmoid(x):
    return torch.sigmoid(x)
def _layernorm(x, axis=-1, eps=1e-5):
    m = x.mean(dim=axis, keepdim=True)
    v = x.var(dim=axis, keepdim=True, unbiased=False)
    return (x - m) / torch.sqrt(v + eps)
def _scatter_add(tgt, idx, src, axis=0):
    return tgt.clone().index_add_(axis, idx, src)
def _segment_sum(src, seg, n):
    out = torch.zeros((n,) + src.shape[1:], dtype=src.dtype)
    return out.index_add_(0, seg, src)
def _pad(x, pw):
    flat = tuple(v for pair in reversed(pw) for v in pair)
    return torch.nn.functional.pad(x, flat)

kernel_name = 'sequential_preLN__ssm_conv_h3__moe_arch_mod__prompt'

def setup_inputs():

    _w = (lambda a: (lambda t: t.to(torch.bfloat16) if t.is_floating_point() else t)(torch.as_tensor(a)))
    def _A_setup():
        B, S, D = 1, 2048, 640
        ks = 4
        return {
            "q": _w((lambda *s: torch.randn(*s, dtype=torch.bfloat16) * 0.05)(B, S, D)),
            "k": _w((lambda *s: torch.randn(*s, dtype=torch.bfloat16) * 0.2)(B, S, D)),
            "v": _w((lambda *s: torch.randn(*s, dtype=torch.bfloat16) * 0.2)(B, S, D)),
            "shift_k": _w((lambda *s: torch.randn(*s, dtype=torch.bfloat16) * 0.2)(D, ks) * 0.5),
            "ssm_k": _w((lambda *s: torch.randn(*s, dtype=torch.bfloat16) * 0.8)(D, S) * (1.0 / S ** 0.5)),
            "ssm_D": _w((lambda *s: torch.randn(*s, dtype=torch.bfloat16) * 0.2)(D)),
        }
    _A_in = _A_setup()

    def _B_setup():
        B, S, D, F, C = 1, 2048, 640, 1536, 2
        return {
            "x": _w((lambda *s: torch.randn(*s, dtype=torch.bfloat16) * 0.05)(B, S, D)),
            "w_r": _w((lambda *s: torch.randn(*s, dtype=torch.bfloat16) * 0.05)(D)),
            "w_gate": _w((lambda *s: torch.randn(*s, dtype=torch.bfloat16) * 0.05)(D, F)),
            "w_up": _w((lambda *s: torch.randn(*s, dtype=torch.bfloat16) * 0.05)(D, F)),
            "w_down": _w((lambda *s: torch.randn(*s, dtype=torch.bfloat16) * 0.05)(F, D)),
        }
    _B_in = _B_setup()

    return {
        "A_q": _A_in["q"],
        "A_k": _A_in["k"],
        "A_v": _A_in["v"],
        "A_shift_k": _A_in["shift_k"],
        "A_ssm_k": _A_in["ssm_k"],
        "A_ssm_D": _A_in["ssm_D"],
        "B_x": _B_in["x"],
        "B_w_r": _B_in["w_r"],
        "B_w_gate": _B_in["w_gate"],
        "B_w_up": _B_in["w_up"],
        "B_w_down": _B_in["w_down"],
    }

def reference(A_q, A_k, A_v, A_shift_k, A_ssm_k, A_ssm_D, B_x, B_w_r, B_w_gate, B_w_up, B_w_down):
    def _A_ref(q, k, v, shift_k, ssm_k, ssm_D):
        B, S, D = q.shape
        ks = shift_k.shape[-1]
        k_pad = _pad(k, ((0, 0), (ks - 1, 0), (0, 0)))
        k_shift = torch.zeros_like(k)
        for t in range(ks):
            k_shift = k_shift + k_pad[:, t:t + S, :] * shift_k[:, ks - 1 - t][None, None, :]
        kv = k_shift * v
        L = 2 * S
        kv_pad = _pad(kv, ((0, 0), (0, S), (0, 0)))
        kf_pad = _pad(ssm_k, ((0, 0), (0, S)))
        kv_f = (lambda x, axes=(-2,-1): torch.fft.rfft2(x.float(), dim=axes))(kv_pad[:, None, :, :], axes=(1, 2))
        kf_f = (lambda x, axes=(-2,-1): torch.fft.rfft2(x.float(), dim=axes))(kf_pad[:, None, :], axes=(1, 2))
        kf_f = (lambda x, *d: x.permute(*d))(kf_f, 1, 2, 0)
        y_f = kv_f * kf_f[None, :, :, :]
        y = (lambda x, s, axes=(-2,-1): torch.fft.irfft2(x, s=s, dim=axes).to(torch.bfloat16))(y_f, (1, L), axes=(1, 2))[:, 0, :S, :]
        y = y + kv * ssm_D[None, None, :]
        return q * y

    def _B_ref(x, w_r, w_gate, w_up, w_down):
        B, S, D = x.shape
        C = 2
        r = x @ w_r
        idx = torch.argsort(-r, axis=-1)[:, :C]
        idx_e = (lambda x, n, axis: torch.repeat_interleave(x, n, dim=axis))(idx.reshape(B, C, 1), D, axis=2)
        x_sel = (lambda x, i, axis: torch.take_along_dim(x, i, dim=axis))(x, idx_e, axis=1)
        g = _silu(x_sel @ w_gate)
        u = x_sel @ w_up
        y = (g * u) @ w_down
        r_sel = _sigmoid((lambda x, i, axis: torch.take_along_dim(x, i, dim=axis))(r, idx, axis=1))
        y = y * r_sel.reshape(B, C, 1)
        b_off = (torch.arange(B) * S).reshape(B, 1)
        flat_idx = (idx + b_off).reshape(B * C)
        zero = (x * 0.0).reshape(B * S, D)
        upd = _scatter_add(zero, flat_idx, y.reshape(B * C, D), axis=0)
        return x + upd.reshape(B, S, D)

    x = A_q
    h = x + _A_ref(_layernorm(x, axis=-1), A_k, A_v, A_shift_k, A_ssm_k, A_ssm_D)
    h2 = h + _B_ref(_layernorm(h, axis=-1), B_w_r, B_w_gate, B_w_up, B_w_down)
    return h2
```

```asm
; @launch grid=(256,1,1) block=(512,1,1) lds=145664
.amdgcn_target "amdgcn-amd-amdhsa--gfx950"
.text
.globl sequential_preLN__ssm_conv_h3__moe_arch_mod__prompt_kernel
.p2align 8
.type sequential_preLN__ssm_conv_h3__moe_arch_mod__prompt_kernel,@function
sequential_preLN__ssm_conv_h3__moe_arch_mod__prompt_kernel:
Lstart:
  s_cmp_ge_u32 s2, 256
  s_cbranch_scc1 Lexit
  s_load_dwordx2 s[20:21], s[0:1], 104
  s_load_dwordx2 s[8:9], s[0:1], 8
  s_load_dwordx2 s[12:13], s[0:1], 16
  s_load_dwordx2 s[16:17], s[0:1], 24
  s_load_dwordx2 s[28:29], s[0:1], 32
  v_lshrrev_b32 v2, 6, v0
  v_and_b32 v1, 63, v0
  s_and_b32 s4, s2, 7
  s_lshr_b32 s5, s2, 3
  v_readfirstlane_b32 s3, v2
  s_mul_i32 s64, s4, 20
  s_mul_i32 s65, s4, 12
  s_add_u32 s65, s65, 140
  s_cmp_lt_u32 s5, 20
  s_cselect_b32 s6, s64, s65
  s_add_u32 s6, s6, s5
  s_cmp_lg_u32 s3, 6
  s_cbranch_scc1 Lnopf
  s_getpc_b64 s[90:91]
Lpc:
  s_sub_u32 s90, s90, Lpc-Lstart
  s_subb_u32 s91, s91, 0
  s_lshl_b32 s63, s5, 6
  s_min_u32 s64, s63, Lexit-Lstart
  s_load_dword s92, s[90:91], s64
  s_add_u32 s63, s63, 2048
  s_min_u32 s64, s63, Lexit-Lstart
  s_load_dword s92, s[90:91], s64
  s_add_u32 s63, s63, 2048
  s_min_u32 s64, s63, Lexit-Lstart
  s_load_dword s92, s[90:91], s64
  s_add_u32 s63, s63, 2048
  s_min_u32 s64, s63, Lexit-Lstart
  s_load_dword s92, s[90:91], s64
  s_add_u32 s63, s63, 2048
  s_min_u32 s64, s63, Lexit-Lstart
  s_load_dword s92, s[90:91], s64
  s_add_u32 s63, s63, 2048
  s_min_u32 s64, s63, Lexit-Lstart
  s_load_dword s92, s[90:91], s64
  s_add_u32 s63, s63, 2048
  s_min_u32 s64, s63, Lexit-Lstart
  s_load_dword s92, s[90:91], s64
  s_add_u32 s63, s63, 2048
  s_min_u32 s64, s63, Lexit-Lstart
  s_load_dword s92, s[90:91], s64
  s_add_u32 s63, s63, 2048
  s_min_u32 s64, s63, Lexit-Lstart
  s_load_dword s92, s[90:91], s64
  s_add_u32 s63, s63, 2048
  s_mov_b32 s22, 4489344
  s_mov_b32 s23, 0x20000
  s_mov_b32 s10, 2621440
  s_mov_b32 s11, 0x20000
  s_mov_b32 s14, 2621440
  s_mov_b32 s15, 0x20000
  s_mov_b32 s18, 5120
  s_mov_b32 s19, 0x20000
  s_mov_b32 s30, 2621440
  s_mov_b32 s31, 0x20000
  v_mov_b32 v232, 0
  s_barrier
  s_branch Lsk
Lnopf:
  s_mul_i32 s63, s6, 10240
  s_lshr_b32 s64, s6, 1
  s_mul_i32 s64, s64, 20480
  s_and_b32 s65, s6, 1
  s_lshl_b32 s65, s65, 6
  s_add_u32 s64, s64, s65
  v_lshlrev_b32 v232, 12, v2
  v_lshrrev_b32 v40, 2, v1
  v_lshl_add_u32 v232, v40, 7, v232
  v_and_b32 v40, 3, v1
  v_lshl_add_u32 v232, v40, 4, v232
  v_add_u32 v232, s64, v232
  v_mov_b32 v40, -1
  v_mov_b32 v41, -1
  v_mov_b32 v42, -1
  v_mov_b32 v43, -1
  v_lshl_add_u32 v3, v0, 2, s63
  v_subrev_u32 v4, 3840, v3
  v_add_u32 v5, 5120, v3
  v_lshlrev_b32 v7, 4, v0
  s_mov_b32 s22, 4489344
  s_mov_b32 s23, 0x20000
  s_mov_b32 s10, 2621440
  s_mov_b32 s11, 0x20000
  s_mov_b32 s14, 2621440
  s_mov_b32 s15, 0x20000
  s_mov_b32 s18, 5120
  s_mov_b32 s19, 0x20000
  s_mov_b32 s30, 2621440
  s_mov_b32 s31, 0x20000
  s_cmp_lt_u32 s3, 5
  s_waitcnt lgkmcnt(0)
  s_cbranch_scc1 Lpre
  s_cmp_lg_u32 s3, 5
  s_cbranch_scc1 Laux1
  s_lshl_b32 s63, s6, 7
  s_add_u32 s63, s63, 4423680
  v_lshlrev_b32 v2, 4, v1
  s_mov_b64 exec, 0xff
  buffer_store_dwordx4 v[40:43], v2, s[20:23], s63 offen sc1
  s_mov_b64 exec, -1
  s_barrier
  s_waitcnt vmcnt(0)
  s_branch Lsk
Laux1:
  v_mov_b32 v4, 4489216
  buffer_load_dword v5, v4, s[20:23], 0 offen sc1
  s_barrier
  v_lshlrev_b32 v2, 2, v1
  v_add_u32 v2, 102528, v2
  v_mov_b32 v4, 0
  s_mov_b64 exec, 0xffff
  ds_write_b32 v2, v4
  s_mov_b64 exec, -1
  s_waitcnt vmcnt(0) lgkmcnt(0)
  v_add_u32 v5, 1, v5
  s_branch Lsk
Lpre:
  buffer_store_dwordx4 v[40:43], v232, s[20:23], 0 offen sc1
  buffer_store_dwordx4 v[40:43], v232, s[20:23], 0 offen offset:2048 sc1
  s_barrier
  buffer_load_dword v10, v4, s[8:11], 0 offen offset:0
  buffer_load_dword v11, v4, s[8:11], 0 offen offset:1280
  buffer_load_dword v12, v4, s[8:11], 0 offen offset:2560
  buffer_load_dword v13, v3, s[8:11], 0 offen offset:0
  buffer_load_dword v14, v3, s[8:11], 0 offen offset:1280
  buffer_load_dword v15, v3, s[8:11], 0 offen offset:2560
  buffer_load_dword v16, v3, s[8:11], 0 offen offset:3840
  buffer_load_dword v17, v5, s[8:11], 0 offen offset:0
  buffer_load_dword v18, v5, s[8:11], 0 offen offset:1280
  buffer_load_dword v19, v5, s[8:11], 0 offen offset:2560
  buffer_load_dword v20, v5, s[8:11], 0 offen offset:3840
  buffer_load_dwordx4 v[30:33], v7, s[16:19], 0 offen
  buffer_load_dword v21, v3, s[12:15], 0 offen offset:0
  buffer_load_dword v22, v3, s[12:15], 0 offen offset:1280
  buffer_load_dword v23, v3, s[12:15], 0 offen offset:2560
  buffer_load_dword v24, v3, s[12:15], 0 offen offset:3840
  buffer_load_dword v25, v5, s[12:15], 0 offen offset:0
  buffer_load_dword v26, v5, s[12:15], 0 offen offset:1280
  buffer_load_dword v27, v5, s[12:15], 0 offen offset:2560
  buffer_load_dword v28, v5, s[12:15], 0 offen offset:3840
Lsk:
  s_load_dwordx2 s[44:45], s[0:1], 40
  s_load_dwordx2 s[32:33], s[0:1], 0
  s_load_dwordx2 s[36:37], s[0:1], 56
  s_load_dwordx2 s[40:41], s[0:1], 88
  s_load_dwordx2 s[48:49], s[0:1], 64
  s_load_dwordx2 s[52:53], s[0:1], 72
  s_load_dwordx2 s[56:57], s[0:1], 80
  s_mov_b32 s46, 1280
  s_mov_b32 s47, 0x20000
  s_mov_b32 s34, 2621440
  s_mov_b32 s35, 0x20000
  s_mov_b32 s38, 1280
  s_mov_b32 s39, 0x20000
  s_mov_b32 s42, 2621440
  s_mov_b32 s43, 0x20000
  s_mov_b32 s50, 1966080
  s_mov_b32 s51, 0x20000
  s_mov_b32 s54, 1966080
  s_mov_b32 s55, 0x20000
  s_mov_b32 s58, 1966080
  s_mov_b32 s59, 0x20000
  s_mul_i32 s64, s4, 20
  s_add_u32 s64, s64, s5
  s_mul_i32 s65, s4, 12
  s_add_u32 s65, s65, s5
  s_sub_u32 s65, s65, 20
  s_cmp_lt_u32 s5, 20
  s_cselect_b32 s7, s64, s65
  s_cselect_b32 s88, 1, 0
  s_lshl_b32 s63, s64, 2
  s_and_b32 s64, s63, 63
  s_lshl_b32 s64, s64, 1
  s_bfe_u32 s65, s63, 0x10006
  s_and_b32 s63, s63, 0xffffff80
  s_add_u32 s62, s63, s64
  s_add_u32 s62, s62, s65
  s_mov_b32 s60, 0xffff0000
  s_mov_b32 s76, 0xfffffffe
  s_mov_b32 s78, 0x00030003
  s_mov_b32 s79, 0x00030003
  s_lshr_b32 s66, s2, 2
  s_lshl_b32 s66, s66, 7
  s_and_b32 s67, s2, 3
  s_lshl_b32 s67, s67, 2
  s_add_u32 s66, s66, s67
  s_add_u32 s66, s66, 4456448
  v_mov_b32 v2, 0
  s_waitcnt vmcnt(20)
  s_barrier
  s_cmp_lt_u32 s3, 5
  s_cbranch_scc1 Lpre1
  s_cmp_lg_u32 s3, 7
  s_cbranch_scc1 Laux2
  s_mov_b64 exec, 1
  buffer_store_dword v5, v2, s[20:23], s66 offen sc1
  s_mov_b64 exec, -1
  s_nop 1
  v_readfirstlane_b32 s89, v5
Laux2:
  s_cmp_eq_u32 s88, 0
  s_waitcnt lgkmcnt(0)
  s_cbranch_scc1 Lffn_aux
  s_cmp_eq_u32 s3, 7
  s_cbranch_scc1 Lcnt
  s_branch Lkst
Lpre1:
  s_lshl_b32 s63, s3, 1
  s_add_u32 s63, s62, s63
  s_lshl_b32 s64, s63, 1
  s_lshl_b32 s63, s63, 12
  s_waitcnt lgkmcnt(0)
  buffer_load_dwordx2 v[34:35], v2, s[28:31], s63 offen
  buffer_load_ushort v36, v2, s[44:47], s64 offen
  s_waitcnt vmcnt(10)
  v_lshlrev_b32 v62, 16, v30
  v_lshlrev_b32 v63, 16, v32
  v_and_b32 v64, s60, v30
  v_and_b32 v65, s60, v32
  v_lshlrev_b32 v66, 16, v31
  v_lshlrev_b32 v67, 16, v33
  v_and_b32 v68, s60, v31
  v_and_b32 v69, s60, v33
  v_and_b32 v41, s60, v10
  v_lshlrev_b32 v40, 16, v10
  v_and_b32 v43, s60, v11
  v_lshlrev_b32 v42, 16, v11
  v_and_b32 v45, s60, v12
  v_lshlrev_b32 v44, 16, v12
  v_and_b32 v47, s60, v13
  v_lshlrev_b32 v46, 16, v13
  v_and_b32 v49, s60, v14
  v_lshlrev_b32 v48, 16, v14
  v_and_b32 v51, s60, v15
  v_lshlrev_b32 v50, 16, v15
  v_and_b32 v53, s60, v16
  v_lshlrev_b32 v52, 16, v16
  v_and_b32 v55, s60, v17
  v_lshlrev_b32 v54, 16, v17
  v_and_b32 v57, s60, v18
  v_lshlrev_b32 v56, 16, v18
  v_and_b32 v59, s60, v19
  v_lshlrev_b32 v58, 16, v19
  v_and_b32 v61, s60, v20
  v_lshlrev_b32 v60, 16, v20
  v_pk_mul_f32 v[86:87], v[40:41], v[68:69]
  v_pk_mul_f32 v[88:89], v[42:43], v[68:69]
  v_pk_mul_f32 v[90:91], v[44:45], v[68:69]
  v_pk_mul_f32 v[92:93], v[46:47], v[68:69]
  v_pk_mul_f32 v[94:95], v[48:49], v[68:69]
  v_pk_mul_f32 v[96:97], v[50:51], v[68:69]
  v_pk_mul_f32 v[98:99], v[52:53], v[68:69]
  v_pk_mul_f32 v[100:101], v[54:55], v[68:69]
  v_pk_fma_f32 v[86:87], v[42:43], v[66:67], v[86:87]
  v_pk_fma_f32 v[88:89], v[44:45], v[66:67], v[88:89]
  v_pk_fma_f32 v[90:91], v[46:47], v[66:67], v[90:91]
  v_pk_fma_f32 v[92:93], v[48:49], v[66:67], v[92:93]
  v_pk_fma_f32 v[94:95], v[50:51], v[66:67], v[94:95]
  v_pk_fma_f32 v[96:97], v[52:53], v[66:67], v[96:97]
  v_pk_fma_f32 v[98:99], v[54:55], v[66:67], v[98:99]
  v_pk_fma_f32 v[100:101], v[56:57], v[66:67], v[100:101]
  v_pk_fma_f32 v[86:87], v[44:45], v[64:65], v[86:87]
  v_pk_fma_f32 v[88:89], v[46:47], v[64:65], v[88:89]
  v_pk_fma_f32 v[90:91], v[48:49], v[64:65], v[90:91]
  v_pk_fma_f32 v[92:93], v[50:51], v[64:65], v[92:93]
  v_pk_fma_f32 v[94:95], v[52:53], v[64:65], v[94:95]
  v_pk_fma_f32 v[96:97], v[54:55], v[64:65], v[96:97]
  v_pk_fma_f32 v[98:99], v[56:57], v[64:65], v[98:99]
  v_pk_fma_f32 v[100:101], v[58:59], v[64:65], v[100:101]
  v_pk_fma_f32 v[86:87], v[46:47], v[62:63], v[86:87]
  v_pk_fma_f32 v[88:89], v[48:49], v[62:63], v[88:89]
  v_pk_fma_f32 v[90:91], v[50:51], v[62:63], v[90:91]
  v_pk_fma_f32 v[92:93], v[52:53], v[62:63], v[92:93]
  v_pk_fma_f32 v[94:95], v[54:55], v[62:63], v[94:95]
  v_pk_fma_f32 v[96:97], v[56:57], v[62:63], v[96:97]
  v_pk_fma_f32 v[98:99], v[58:59], v[62:63], v[98:99]
  v_pk_fma_f32 v[100:101], v[60:61], v[62:63], v[100:101]
  s_waitcnt vmcnt(2)
  v_and_b32 v71, s60, v21
  v_lshlrev_b32 v70, 16, v21
  v_and_b32 v73, s60, v22
  v_lshlrev_b32 v72, 16, v22
  v_and_b32 v75, s60, v23
  v_lshlrev_b32 v74, 16, v23
  v_and_b32 v77, s60, v24
  v_lshlrev_b32 v76, 16, v24
  v_and_b32 v79, s60, v25
  v_lshlrev_b32 v78, 16, v25
  v_and_b32 v81, s60, v26
  v_lshlrev_b32 v80, 16, v26
  v_and_b32 v83, s60, v27
  v_lshlrev_b32 v82, 16, v27
  v_and_b32 v85, s60, v28
  v_lshlrev_b32 v84, 16, v28
  v_pk_mul_f32 v[86:87], v[86:87], v[70:71]
  v_pk_mul_f32 v[88:89], v[88:89], v[72:73]
  v_pk_mul_f32 v[90:91], v[90:91], v[74:75]
  v_pk_mul_f32 v[92:93], v[92:93], v[76:77]
  v_pk_mul_f32 v[94:95], v[94:95], v[78:79]
  v_pk_mul_f32 v[96:97], v[96:97], v[80:81]
  v_pk_mul_f32 v[98:99], v[98:99], v[82:83]
  v_pk_mul_f32 v[100:101], v[100:101], v[84:85]
  v_cvt_pk_bf16_f32 v224, v100, v98
  v_cvt_pk_bf16_f32 v225, v96, v94
  v_cvt_pk_bf16_f32 v226, v92, v90
  v_cvt_pk_bf16_f32 v227, v88, v86
  v_min_u32 v224, s76, v224
  v_min_u32 v225, s76, v225
  v_min_u32 v226, s76, v226
  v_min_u32 v227, s76, v227
  buffer_store_dwordx4 v[224:227], v232, s[20:23], 0 offen offset:0 sc1
  v_cvt_pk_bf16_f32 v228, v101, v99
  v_cvt_pk_bf16_f32 v229, v97, v95
  v_cvt_pk_bf16_f32 v230, v93, v91
  v_cvt_pk_bf16_f32 v231, v89, v87
  v_min_u32 v228, s76, v228
  v_min_u32 v229, s76, v229
  v_min_u32 v230, s76, v230
  v_min_u32 v231, s76, v231
  buffer_store_dwordx4 v[228:231], v232, s[20:23], 0 offen offset:2048 sc1
  s_cmp_eq_u32 s88, 0
  s_cbranch_scc1 Lffn_pre
  s_cmp_eq_u32 s3, 4
  s_cbranch_scc1 Lb1h
  v_lshrrev_b32 v10, 2, v0
  v_add_u32 v10, 160, v10
  v_and_b32 v11, 3, v0
  v_lshrrev_b32 v16, 1, v10
  v_mul_u32_u24 v16, 20480, v16
  v_and_b32 v12, 1, v10
  v_lshl_add_u32 v16, v12, 6, v16
  v_lshl_add_u32 v16, v11, 4, v16
  s_lshl_b32 s67, s7, 7
  v_add_u32 v28, s67, v16
  v_mul_u32_u24 v29, 4640, v11
  v_lshl_add_u32 v29, v10, 4, v29
  v_add_u32 v29, 127104, v29
  v_and_b32 v4, 15, v1
  v_lshrrev_b32 v5, 4, v1
  v_add_u32 v10, 1, v4
  v_and_b32 v11, 3, v10
  v_mul_u32_u24 v11, 4160, v11
  v_lshrrev_b32 v10, 2, v10
  v_lshl_add_u32 v10, v5, 1, v10
  v_lshl_add_u32 v8, v10, 3, v11
  s_mul_i32 s65, s3, 16640
  v_add_u32 v8, s65, v8
  v_lshlrev_b32 v10, 1, v4
  v_sub_u32 v10, v10, v5
  v_lshlrev_b32 v10, 4, v10
  s_mul_i32 s66, s3, 4640
  s_add_u32 s66, s66, 66560
  v_add_u32 v9, s66, v10
  v_add_u32 v9, 80, v9
  v_and_b32 v10, 1, v5
  v_lshlrev_b32 v10, 5, v10
  v_lshl_add_u32 v10, v4, 1, v10
  v_lshrrev_b32 v11, 1, v5
  v_add_u32 v10, v10, v11
  v_lshl_add_u32 v6, v10, 4, s66
  v_and_b32 v10, 31, v10
  v_lshl_add_u32 v7, v10, 4, s66
  s_lshl_b32 s63, s3, 2
  s_add_u32 s63, s63, 102544
  v_mov_b32 v30, s63
  v_mov_b32 v31, 1
  v_mov_b32 v12, 0
  v_mov_b32 v13, 0
  v_mov_b32 v14, 0
  v_mov_b32 v15, 0
  v_lshl_add_u32 v10, v1, 4, s66
  s_mov_b32 exec_hi, 0
  ds_write_b128 v10, v[12:15]
  s_mov_b32 exec_hi, -1
  v_lshrrev_b32 v10, 2, v1
  v_and_b32 v11, 3, v1
  s_lshl_b32 s67, s3, 6
  v_add_u32 v10, s67, v10
  v_lshrrev_b32 v16, 1, v10
  v_mul_u32_u24 v16, 20480, v16
  v_and_b32 v12, 1, v10
  v_lshl_add_u32 v16, v12, 6, v16
  v_lshl_add_u32 v16, v11, 4, v16
  s_lshl_b32 s67, s7, 7
  v_add_u32 v16, s67, v16
  v_mul_u32_u24 v17, 4640, v11
  v_lshl_add_u32 v17, v10, 4, v17
  v_add_u32 v17, 67072, v17
  s_mov_b32 s68, 163840
  s_mov_b32 s69, 327680
  s_mov_b32 s70, 491520
  s_mov_b32 s61, 0
  s_waitcnt vmcnt(2)
  v_lshlrev_b32 v12, 16, v34
  v_lshlrev_b32 v13, 16, v36
  v_add_f32 v12, v12, v13
  v_cvt_pk_bf16_f32 v12, v12, v12
  v_bfi_b32 v34, s60, v34, v12
  v_lshlrev_b32 v12, 16, v34
  v_alignbit_b32 v13, v35, v34, 16
  v_cmp_eq_u32 vcc, 7, v1
  s_nop 1
  v_cndmask_b32 v14, 0, v12, vcc
  v_cndmask_b32 v15, 0, v13, vcc
  v_cmp_eq_u32 vcc, 5, v1
  s_nop 1
  v_cndmask_b32 v15, v15, v34, vcc
  v_cmp_eq_u32 vcc, 3, v1
  s_nop 1
  v_cndmask_b32 v15, v15, v12, vcc
  v_mov_b32 v12, 0
  v_mov_b32 v13, 0
  v_lshrrev_b32 v10, 1, v1
  v_mul_u32_u24 v10, 4160, v10
  v_and_b32 v11, 1, v1
  v_lshl_add_u32 v10, v11, 4, v10
  v_add_u32 v10, s65, v10
  s_mov_b64 exec, 0xff
  ds_write_b128 v10, v[12:15]
  s_mov_b64 exec, -1
  v_mov_b32 v2, 102528
  s_waitcnt vmcnt(0)
Lf1:
  ds_read_b32 v20, v2
  s_waitcnt lgkmcnt(0)
  v_cmp_eq_u32 vcc, 0, v20
  s_cbranch_vccnz Lf1
Lu:
  buffer_load_dwordx4 v[128:131], v16, s[20:23], 0 offen sc1
  buffer_load_dwordx4 v[132:135], v16, s[20:23], s68 offen sc1
  buffer_load_dwordx4 v[136:139], v16, s[20:23], s69 offen sc1
  buffer_load_dwordx4 v[140:143], v16, s[20:23], s70 offen sc1
  s_cmp_lg_u32 s61, 0
  s_cbranch_scc1 Lu1
Lk:
  ds_read_b64 v[20:21], v2 offset:8
  s_waitcnt lgkmcnt(0)
  v_min_u32 v20, v20, v21
  v_cmp_eq_u32 vcc, 0, v20
  s_cbranch_vccnz Lk
  ds_read_b64 v[64:65], v8 offset:0
  ds_read_b64 v[66:67], v8 offset:8
  ds_read_b64 v[68:69], v8 offset:512
  ds_read_b64 v[70:71], v8 offset:520
  ds_read_b64 v[72:73], v8 offset:1024
  ds_read_b64 v[74:75], v8 offset:1032
  ds_read_b64 v[76:77], v8 offset:1536
  ds_read_b64 v[78:79], v8 offset:1544
  ds_read_b64 v[80:81], v8 offset:2048
  ds_read_b64 v[82:83], v8 offset:2056
  ds_read_b64 v[84:85], v8 offset:2560
  ds_read_b64 v[86:87], v8 offset:2568
  ds_read_b64 v[88:89], v8 offset:3072
  ds_read_b64 v[90:91], v8 offset:3080
  ds_read_b64 v[92:93], v8 offset:3584
  ds_read_b64 v[94:95], v8 offset:3592
Lu1:
  s_waitcnt vmcnt(3)
  ds_write_b128 v17, v[128:131] offset:0
  s_waitcnt vmcnt(2)
  ds_write_b128 v17, v[132:135] offset:256
  s_waitcnt vmcnt(1)
  ds_write_b128 v17, v[136:139] offset:512
  s_waitcnt vmcnt(0)
  ds_write_b128 v17, v[140:143] offset:768
  v_max3_u32 v18, v128, v129, v130
  v_max3_u32 v19, v131, v132, v133
  v_max3_u32 v18, v18, v134, v135
  v_max3_u32 v19, v19, v136, v137
  v_max3_u32 v18, v18, v138, v139
  v_max3_u32 v19, v19, v140, v141
  v_max3_u32 v18, v18, v142, v143
  v_max_u32 v18, v18, v19
  v_cmp_eq_u32 vcc, -1, v18
  s_cbranch_vccz Luok
  s_mov_b64 exec, vcc
  s_add_u32 s61, s61, 1
  s_cmp_lt_u32 s61, 40000
  s_cbranch_scc1 Lu
Luok:
  s_mov_b64 exec, -1
  s_waitcnt lgkmcnt(0)
  s_barrier
  ds_read_b128 v[96:99], v9 offset:448
  ds_read_b128 v[100:103], v9 offset:960
  ds_read_b128 v[104:107], v9 offset:1472
  ds_read_b128 v[108:111], v9 offset:1984
  ds_read_b128 v[112:115], v9 offset:2496
  ds_read_b128 v[116:119], v9 offset:3008
  ds_read_b128 v[120:123], v9 offset:3520
  ds_read_b128 v[124:127], v9 offset:4032
  s_setprio 1
  s_waitcnt lgkmcnt(7)
  v_mfma_f32_16x16x32_bf16 v[32:35], v[64:67], v[96:99], 0
  ds_read_b128 v[160:163], v9 offset:384
  v_mfma_f32_16x16x32_bf16 v[36:39], v[68:71], v[96:99], 0
  ds_read_b64 v[128:129], v8 offset:64
  v_mfma_f32_16x16x32_bf16 v[40:43], v[72:75], v[96:99], 0
  ds_read_b64 v[130:131], v8 offset:72
  v_mfma_f32_16x16x32_bf16 v[44:47], v[76:79], v[96:99], 0
  ds_read_b64 v[132:133], v8 offset:576
  v_mfma_f32_16x16x32_bf16 v[48:51], v[80:83], v[96:99], 0
  ds_read_b64 v[134:135], v8 offset:584
  v_mfma_f32_16x16x32_bf16 v[52:55], v[84:87], v[96:99], 0
  ds_read_b64 v[136:137], v8 offset:1088
  v_mfma_f32_16x16x32_bf16 v[56:59], v[88:91], v[96:99], 0
  ds_read_b64 v[138:139], v8 offset:1096
  v_mfma_f32_16x16x32_bf16 v[60:63], v[92:95], v[96:99], 0
  ds_read_b64 v[140:141], v8 offset:1600
  s_waitcnt lgkmcnt(12)
  v_mfma_f32_16x16x32_bf16 v[36:39], v[64:67], v[100:103], v[36:39]
  ds_read_b64 v[142:143], v8 offset:1608
  v_mfma_f32_16x16x32_bf16 v[40:43], v[68:71], v[100:103], v[40:43]
  ds_read_b64 v[144:145], v8 offset:2112
  v_mfma_f32_16x16x32_bf16 v[44:47], v[72:75], v[100:103], v[44:47]
  ds_read_b64 v[146:147], v8 offset:2120
  v_mfma_f32_16x16x32_bf16 v[48:51], v[76:79], v[100:103], v[48:51]
  ds_read_b64 v[148:149], v8 offset:2624
  v_mfma_f32_16x16x32_bf16 v[52:55], v[80:83], v[100:103], v[52:55]
  ds_read_b64 v[150:151], v8 offset:2632
  v_mfma_f32_16x16x32_bf16 v[56:59], v[84:87], v[100:103], v[56:59]
  ds_read_b64 v[152:153], v8 offset:3136
  v_mfma_f32_16x16x32_bf16 v[60:63], v[88:91], v[100:103], v[60:63]
  ds_read_b64 v[154:155], v8 offset:3144
  v_mfma_f32_16x16x32_bf16 v[40:43], v[64:67], v[104:107], v[40:43]
  ds_read_b64 v[156:157], v8 offset:3648
  v_mfma_f32_16x16x32_bf16 v[44:47], v[68:71], v[104:107], v[44:47]
  ds_read_b64 v[158:159], v8 offset:3656
  v_mfma_f32_16x16x32_bf16 v[48:51], v[72:75], v[104:107], v[48:51]
  ds_read_b128 v[164:167], v9 offset:896
  v_mfma_f32_16x16x32_bf16 v[52:55], v[76:79], v[104:107], v[52:55]
  ds_read_b128 v[168:171], v9 offset:1408
  v_mfma_f32_16x16x32_bf16 v[56:59], v[80:83], v[104:107], v[56:59]
  ds_read_b128 v[172:175], v9 offset:1920
  v_mfma_f32_16x16x32_bf16 v[60:63], v[84:87], v[104:107], v[60:63]
  ds_read_b128 v[176:179], v9 offset:2432
  v_mfma_f32_16x16x32_bf16 v[44:47], v[64:67], v[108:111], v[44:47]
  ds_read_b128 v[180:183], v9 offset:2944
  v_mfma_f32_16x16x32_bf16 v[48:51], v[68:71], v[108:111], v[48:51]
  ds_read_b128 v[184:187], v9 offset:3456
  v_mfma_f32_16x16x32_bf16 v[52:55], v[72:75], v[108:111], v[52:55]
  ds_read_b128 v[188:191], v9 offset:3968
  v_mfma_f32_16x16x32_bf16 v[56:59], v[76:79], v[108:111], v[56:59]
  v_mfma_f32_16x16x32_bf16 v[60:63], v[80:83], v[108:111], v[60:63]
  s_waitcnt lgkmcnt(13)
  v_mfma_f32_16x16x32_bf16 v[48:51], v[64:67], v[112:115], v[48:51]
  v_mfma_f32_16x16x32_bf16 v[52:55], v[68:71], v[112:115], v[52:55]
  v_mfma_f32_16x16x32_bf16 v[56:59], v[72:75], v[112:115], v[56:59]
  v_mfma_f32_16x16x32_bf16 v[60:63], v[76:79], v[112:115], v[60:63]
  v_mfma_f32_16x16x32_bf16 v[52:55], v[64:67], v[116:119], v[52:55]
  v_mfma_f32_16x16x32_bf16 v[56:59], v[68:71], v[116:119], v[56:59]
  v_mfma_f32_16x16x32_bf16 v[60:63], v[72:75], v[116:119], v[60:63]
  v_mfma_f32_16x16x32_bf16 v[56:59], v[64:67], v[120:123], v[56:59]
  v_mfma_f32_16x16x32_bf16 v[60:63], v[68:71], v[120:123], v[60:63]
  v_mfma_f32_16x16x32_bf16 v[60:63], v[64:67], v[124:127], v[60:63]
  s_waitcnt lgkmcnt(0)
  v_mfma_f32_16x16x32_bf16 v[32:35], v[128:131], v[160:163], v[32:35]
  ds_read_b128 v[96:99], v9 offset:320
  v_mfma_f32_16x16x32_bf16 v[36:39], v[132:135], v[160:163], v[36:39]
  ds_read_b64 v[64:65], v8 offset:128
  v_mfma_f32_16x16x32_bf16 v[40:43], v[136:139], v[160:163], v[40:43]
  ds_read_b64 v[66:67], v8 offset:136
  v_mfma_f32_16x16x32_bf16 v[44:47], v[140:143], v[160:163], v[44:47]
  ds_read_b64 v[68:69], v8 offset:640
  v_mfma_f32_16x16x32_bf16 v[48:51], v[144:147], v[160:163], v[48:51]
  ds_read_b64 v[70:71], v8 offset:648
  v_mfma_f32_16x16x32_bf16 v[52:55], v[148:151], v[160:163], v[52:55]
  ds_read_b64 v[72:73], v8 offset:1152
  v_mfma_f32_16x16x32_bf16 v[56:59], v[152:155], v[160:163], v[56:59]
  ds_read_b64 v[74:75], v8 offset:1160
  v_mfma_f32_16x16x32_bf16 v[60:63], v[156:159], v[160:163], v[60:63]
  ds_read_b64 v[76:77], v8 offset:1664
  v_mfma_f32_16x16x32_bf16 v[36:39], v[128:131], v[164:167], v[36:39]
  ds_read_b64 v[78:79], v8 offset:1672
  v_mfma_f32_16x16x32_bf16 v[40:43], v[132:135], v[164:167], v[40:43]
  ds_read_b64 v[80:81], v8 offset:2176
  v_mfma_f32_16x16x32_bf16 v[44:47], v[136:139], v[164:167], v[44:47]
  ds_read_b64 v[82:83], v8 offset:2184
  v_mfma_f32_16x16x32_bf16 v[48:51], v[140:143], v[164:167], v[48:51]
  ds_read_b64 v[84:85], v8 offset:2688
  v_mfma_f32_16x16x32_bf16 v[52:55], v[144:147], v[164:167], v[52:55]
  ds_read_b64 v[86:87], v8 offset:2696
  v_mfma_f32_16x16x32_bf16 v[56:59], v[148:151], v[164:167], v[56:59]
  ds_read_b64 v[88:89], v8 offset:3200
  v_mfma_f32_16x16x32_bf16 v[60:63], v[152:155], v[164:167], v[60:63]
  ds_read_b64 v[90:91], v8 offset:3208
  v_mfma_f32_16x16x32_bf16 v[40:43], v[128:131], v[168:171], v[40:43]
  ds_read_b64 v[92:93], v8 offset:3712
  v_mfma_f32_16x16x32_bf16 v[44:47], v[132:135], v[168:171], v[44:47]
  ds_read_b64 v[94:95], v8 offset:3720
  v_mfma_f32_16x16x32_bf16 v[48:51], v[136:139], v[168:171], v[48:51]
  ds_read_b128 v[100:103], v9 offset:832
  v_mfma_f32_16x16x32_bf16 v[52:55], v[140:143], v[168:171], v[52:55]
  ds_read_b128 v[104:107], v9 offset:1344
  v_mfma_f32_16x16x32_bf16 v[56:59], v[144:147], v[168:171], v[56:59]
  ds_read_b128 v[108:111], v9 offset:1856
  v_mfma_f32_16x16x32_bf16 v[60:63], v[148:151], v[168:171], v[60:63]
  ds_read_b128 v[112:115], v9 offset:2368
  v_mfma_f32_16x16x32_bf16 v[44:47], v[128:131], v[172:175], v[44:47]
  ds_read_b128 v[116:119], v9 offset:2880
  v_mfma_f32_16x16x32_bf16 v[48:51], v[132:135], v[172:175], v[48:51]
  ds_read_b128 v[120:123], v9 offset:3392
  v_mfma_f32_16x16x32_bf16 v[52:55], v[136:139], v[172:175], v[52:55]
  ds_read_b128 v[124:127], v9 offset:3904
  v_mfma_f32_16x16x32_bf16 v[56:59], v[140:143], v[172:175], v[56:59]
  v_mfma_f32_16x16x32_bf16 v[60:63], v[144:147], v[172:175], v[60:63]
  v_mfma_f32_16x16x32_bf16 v[48:51], v[128:131], v[176:179], v[48:51]
  v_mfma_f32_16x16x32_bf16 v[52:55], v[132:135], v[176:179], v[52:55]
  v_mfma_f32_16x16x32_bf16 v[56:59], v[136:139], v[176:179], v[56:59]
  v_mfma_f32_16x16x32_bf16 v[60:63], v[140:143], v[176:179], v[60:63]
  v_mfma_f32_16x16x32_bf16 v[52:55], v[128:131], v[180:183], v[52:55]
  v_mfma_f32_16x16x32_bf16 v[56:59], v[132:135], v[180:183], v[56:59]
  v_mfma_f32_16x16x32_bf16 v[60:63], v[136:139], v[180:183], v[60:63]
  v_mfma_f32_16x16x32_bf16 v[56:59], v[128:131], v[184:187], v[56:59]
  v_mfma_f32_16x16x32_bf16 v[60:63], v[132:135], v[184:187], v[60:63]
  v_mfma_f32_16x16x32_bf16 v[60:63], v[128:131], v[188:191], v[60:63]
  s_waitcnt lgkmcnt(0)
  v_mfma_f32_16x16x32_bf16 v[32:35], v[64:67], v[96:99], v[32:35]
  ds_read_b128 v[160:163], v9 offset:256
  v_mfma_f32_16x16x32_bf16 v[36:39], v[68:71], v[96:99], v[36:39]
  ds_read_b64 v[128:129], v8 offset:192
  v_mfma_f32_16x16x32_bf16 v[40:43], v[72:75], v[96:99], v[40:43]
  ds_read_b64 v[130:131], v8 offset:200
  v_mfma_f32_16x16x32_bf16 v[44:47], v[76:79], v[96:99], v[44:47]
  ds_read_b64 v[132:133], v8 offset:704
  v_mfma_f32_16x16x32_bf16 v[48:51], v[80:83], v[96:99], v[48:51]
  ds_read_b64 v[134:135], v8 offset:712
  v_mfma_f32_16x16x32_bf16 v[52:55], v[84:87], v[96:99], v[52:55]
  ds_read_b64 v[136:137], v8 offset:1216
  v_mfma_f32_16x16x32_bf16 v[56:59], v[88:91], v[96:99], v[56:59]
  ds_read_b64 v[138:139], v8 offset:1224
  v_mfma_f32_16x16x32_bf16 v[60:63], v[92:95], v[96:99], v[60:63]
  ds_read_b64 v[140:141], v8 offset:1728
  v_mfma_f32_16x16x32_bf16 v[36:39], v[64:67], v[100:103], v[36:39]
  ds_read_b64 v[142:143], v8 offset:1736
  v_mfma_f32_16x16x32_bf16 v[40:43], v[68:71], v[100:103], v[40:43]
  ds_read_b64 v[144:145], v8 offset:2240
  v_mfma_f32_16x16x32_bf16 v[44:47], v[72:75], v[100:103], v[44:47]
  ds_read_b64 v[146:147], v8 offset:2248
  v_mfma_f32_16x16x32_bf16 v[48:51], v[76:79], v[100:103], v[48:51]
  ds_read_b64 v[148:149], v8 offset:2752
  v_mfma_f32_16x16x32_bf16 v[52:55], v[80:83], v[100:103], v[52:55]
  ds_read_b64 v[150:151], v8 offset:2760
  v_mfma_f32_16x16x32_bf16 v[56:59], v[84:87], v[100:103], v[56:59]
  ds_read_b64 v[152:153], v8 offset:3264
  v_mfma_f32_16x16x32_bf16 v[60:63], v[88:91], v[100:103], v[60:63]
  ds_read_b64 v[154:155], v8 offset:3272
  v_mfma_f32_16x16x32_bf16 v[40:43], v[64:67], v[104:107], v[40:43]
  ds_read_b64 v[156:157], v8 offset:3776
  v_mfma_f32_16x16x32_bf16 v[44:47], v[68:71], v[104:107], v[44:47]
  ds_read_b64 v[158:159], v8 offset:3784
  v_mfma_f32_16x16x32_bf16 v[48:51], v[72:75], v[104:107], v[48:51]
  ds_read_b128 v[164:167], v9 offset:768
  v_mfma_f32_16x16x32_bf16 v[52:55], v[76:79], v[104:107], v[52:55]
  ds_read_b128 v[168:171], v9 offset:1280
  v_mfma_f32_16x16x32_bf16 v[56:59], v[80:83], v[104:107], v[56:59]
  ds_read_b128 v[172:175], v9 offset:1792
  v_mfma_f32_16x16x32_bf16 v[60:63], v[84:87], v[104:107], v[60:63]
  ds_read_b128 v[176:179], v9 offset:2304
  v_mfma_f32_16x16x32_bf16 v[44:47], v[64:67], v[108:111], v[44:47]
  ds_read_b128 v[180:183], v9 offset:2816
  v_mfma_f32_16x16x32_bf16 v[48:51], v[68:71], v[108:111], v[48:51]
  ds_read_b128 v[184:187], v9 offset:3328
  v_mfma_f32_16x16x32_bf16 v[52:55], v[72:75], v[108:111], v[52:55]
  ds_read_b128 v[188:191], v9 offset:3840
  v_mfma_f32_16x16x32_bf16 v[56:59], v[76:79], v[108:111], v[56:59]
  v_mfma_f32_16x16x32_bf16 v[60:63], v[80:83], v[108:111], v[60:63]
  v_mfma_f32_16x16x32_bf16 v[48:51], v[64:67], v[112:115], v[48:51]
  v_mfma_f32_16x16x32_bf16 v[52:55], v[68:71], v[112:115], v[52:55]
  v_mfma_f32_16x16x32_bf16 v[56:59], v[72:75], v[112:115], v[56:59]
  v_mfma_f32_16x16x32_bf16 v[60:63], v[76:79], v[112:115], v[60:63]
  v_mfma_f32_16x16x32_bf16 v[52:55], v[64:67], v[116:119], v[52:55]
  v_mfma_f32_16x16x32_bf16 v[56:59], v[68:71], v[116:119], v[56:59]
  v_mfma_f32_16x16x32_bf16 v[60:63], v[72:75], v[116:119], v[60:63]
  v_mfma_f32_16x16x32_bf16 v[56:59], v[64:67], v[120:123], v[56:59]
  v_mfma_f32_16x16x32_bf16 v[60:63], v[68:71], v[120:123], v[60:63]
  v_mfma_f32_16x16x32_bf16 v[60:63], v[64:67], v[124:127], v[60:63]
  s_waitcnt lgkmcnt(0)
  v_mfma_f32_16x16x32_bf16 v[32:35], v[128:131], v[160:163], v[32:35]
  ds_read_b128 v[96:99], v9 offset:192
  v_mfma_f32_16x16x32_bf16 v[36:39], v[132:135], v[160:163], v[36:39]
  ds_read_b64 v[64:65], v8 offset:256
  v_mfma_f32_16x16x32_bf16 v[40:43], v[136:139], v[160:163], v[40:43]
  ds_read_b64 v[66:67], v8 offset:264
  v_mfma_f32_16x16x32_bf16 v[44:47], v[140:143], v[160:163], v[44:47]
  ds_read_b64 v[68:69], v8 offset:768
  v_mfma_f32_16x16x32_bf16 v[48:51], v[144:147], v[160:163], v[48:51]
  ds_read_b64 v[70:71], v8 offset:776
  v_mfma_f32_16x16x32_bf16 v[52:55], v[148:151], v[160:163], v[52:55]
  ds_read_b64 v[72:73], v8 offset:1280
  v_mfma_f32_16x16x32_bf16 v[56:59], v[152:155], v[160:163], v[56:59]
  ds_read_b64 v[74:75], v8 offset:1288
  v_mfma_f32_16x16x32_bf16 v[60:63], v[156:159], v[160:163], v[60:63]
  ds_read_b64 v[76:77], v8 offset:1792
  v_mfma_f32_16x16x32_bf16 v[36:39], v[128:131], v[164:167], v[36:39]
  ds_read_b64 v[78:79], v8 offset:1800
  v_mfma_f32_16x16x32_bf16 v[40:43], v[132:135], v[164:167], v[40:43]
  ds_read_b64 v[80:81], v8 offset:2304
  v_mfma_f32_16x16x32_bf16 v[44:47], v[136:139], v[164:167], v[44:47]
  ds_read_b64 v[82:83], v8 offset:2312
  v_mfma_f32_16x16x32_bf16 v[48:51], v[140:143], v[164:167], v[48:51]
  ds_read_b64 v[84:85], v8 offset:2816
  v_mfma_f32_16x16x32_bf16 v[52:55], v[144:147], v[164:167], v[52:55]
  ds_read_b64 v[86:87], v8 offset:2824
  v_mfma_f32_16x16x32_bf16 v[56:59], v[148:151], v[164:167], v[56:59]
  ds_read_b64 v[88:89], v8 offset:3328
  v_mfma_f32_16x16x32_bf16 v[60:63], v[152:155], v[164:167], v[60:63]
  ds_read_b64 v[90:91], v8 offset:3336
  v_mfma_f32_16x16x32_bf16 v[40:43], v[128:131], v[168:171], v[40:43]
  ds_read_b64 v[92:93], v8 offset:3840
  v_mfma_f32_16x16x32_bf16 v[44:47], v[132:135], v[168:171], v[44:47]
  ds_read_b64 v[94:95], v8 offset:3848
  v_mfma_f32_16x16x32_bf16 v[48:51], v[136:139], v[168:171], v[48:51]
  ds_read_b128 v[100:103], v9 offset:704
  v_mfma_f32_16x16x32_bf16 v[52:55], v[140:143], v[168:171], v[52:55]
  ds_read_b128 v[104:107], v9 offset:1216
  v_mfma_f32_16x16x32_bf16 v[56:59], v[144:147], v[168:171], v[56:59]
  ds_read_b128 v[108:111], v9 offset:1728
  v_mfma_f32_16x16x32_bf16 v[60:63], v[148:151], v[168:171], v[60:63]
  ds_read_b128 v[112:115], v9 offset:2240
  v_mfma_f32_16x16x32_bf16 v[44:47], v[128:131], v[172:175], v[44:47]
  ds_read_b128 v[116:119], v9 offset:2752
  v_mfma_f32_16x16x32_bf16 v[48:51], v[132:135], v[172:175], v[48:51]
  ds_read_b128 v[120:123], v9 offset:3264
  v_mfma_f32_16x16x32_bf16 v[52:55], v[136:139], v[172:175], v[52:55]
  ds_read_b128 v[124:127], v9 offset:3776
  v_mfma_f32_16x16x32_bf16 v[56:59], v[140:143], v[172:175], v[56:59]
  v_mfma_f32_16x16x32_bf16 v[60:63], v[144:147], v[172:175], v[60:63]
  v_mfma_f32_16x16x32_bf16 v[48:51], v[128:131], v[176:179], v[48:51]
  v_mfma_f32_16x16x32_bf16 v[52:55], v[132:135], v[176:179], v[52:55]
  v_mfma_f32_16x16x32_bf16 v[56:59], v[136:139], v[176:179], v[56:59]
  v_mfma_f32_16x16x32_bf16 v[60:63], v[140:143], v[176:179], v[60:63]
  v_mfma_f32_16x16x32_bf16 v[52:55], v[128:131], v[180:183], v[52:55]
  v_mfma_f32_16x16x32_bf16 v[56:59], v[132:135], v[180:183], v[56:59]
  v_mfma_f32_16x16x32_bf16 v[60:63], v[136:139], v[180:183], v[60:63]
  v_mfma_f32_16x16x32_bf16 v[56:59], v[128:131], v[184:187], v[56:59]
  v_mfma_f32_16x16x32_bf16 v[60:63], v[132:135], v[184:187], v[60:63]
  v_mfma_f32_16x16x32_bf16 v[60:63], v[128:131], v[188:191], v[60:63]
  s_waitcnt lgkmcnt(0)
  v_mfma_f32_16x16x32_bf16 v[32:35], v[64:67], v[96:99], v[32:35]
  ds_read_b128 v[160:163], v9 offset:128
  v_mfma_f32_16x16x32_bf16 v[36:39], v[68:71], v[96:99], v[36:39]
  ds_read_b64 v[128:129], v8 offset:320
  v_mfma_f32_16x16x32_bf16 v[40:43], v[72:75], v[96:99], v[40:43]
  ds_read_b64 v[130:131], v8 offset:328
  v_mfma_f32_16x16x32_bf16 v[44:47], v[76:79], v[96:99], v[44:47]
  ds_read_b64 v[132:133], v8 offset:832
  v_mfma_f32_16x16x32_bf16 v[48:51], v[80:83], v[96:99], v[48:51]
  ds_read_b64 v[134:135], v8 offset:840
  v_mfma_f32_16x16x32_bf16 v[52:55], v[84:87], v[96:99], v[52:55]
  ds_read_b64 v[136:137], v8 offset:1344
  v_mfma_f32_16x16x32_bf16 v[56:59], v[88:91], v[96:99], v[56:59]
  ds_read_b64 v[138:139], v8 offset:1352
  v_mfma_f32_16x16x32_bf16 v[60:63], v[92:95], v[96:99], v[60:63]
  ds_read_b64 v[140:141], v8 offset:1856
  v_mfma_f32_16x16x32_bf16 v[36:39], v[64:67], v[100:103], v[36:39]
  ds_read_b64 v[142:143], v8 offset:1864
  v_mfma_f32_16x16x32_bf16 v[40:43], v[68:71], v[100:103], v[40:43]
  ds_read_b64 v[144:145], v8 offset:2368
  v_mfma_f32_16x16x32_bf16 v[44:47], v[72:75], v[100:103], v[44:47]
  ds_read_b64 v[146:147], v8 offset:2376
  v_mfma_f32_16x16x32_bf16 v[48:51], v[76:79], v[100:103], v[48:51]
  ds_read_b64 v[148:149], v8 offset:2880
  v_mfma_f32_16x16x32_bf16 v[52:55], v[80:83], v[100:103], v[52:55]
  ds_read_b64 v[150:151], v8 offset:2888
  v_mfma_f32_16x16x32_bf16 v[56:59], v[84:87], v[100:103], v[56:59]
  ds_read_b64 v[152:153], v8 offset:3392
  v_mfma_f32_16x16x32_bf16 v[60:63], v[88:91], v[100:103], v[60:63]
  ds_read_b64 v[154:155], v8 offset:3400
  v_mfma_f32_16x16x32_bf16 v[40:43], v[64:67], v[104:107], v[40:43]
  ds_read_b64 v[156:157], v8 offset:3904
  v_mfma_f32_16x16x32_bf16 v[44:47], v[68:71], v[104:107], v[44:47]
  ds_read_b64 v[158:159], v8 offset:3912
  v_mfma_f32_16x16x32_bf16 v[48:51], v[72:75], v[104:107], v[48:51]
  ds_read_b128 v[164:167], v9 offset:640
  v_mfma_f32_16x16x32_bf16 v[52:55], v[76:79], v[104:107], v[52:55]
  ds_read_b128 v[168:171], v9 offset:1152
  v_mfma_f32_16x16x32_bf16 v[56:59], v[80:83], v[104:107], v[56:59]
  ds_read_b128 v[172:175], v9 offset:1664
  v_mfma_f32_16x16x32_bf16 v[60:63], v[84:87], v[104:107], v[60:63]
  ds_read_b128 v[176:179], v9 offset:2176
  v_mfma_f32_16x16x32_bf16 v[44:47], v[64:67], v[108:111], v[44:47]
  ds_read_b128 v[180:183], v9 offset:2688
  v_mfma_f32_16x16x32_bf16 v[48:51], v[68:71], v[108:111], v[48:51]
  ds_read_b128 v[184:187], v9 offset:3200
  v_mfma_f32_16x16x32_bf16 v[52:55], v[72:75], v[108:111], v[52:55]
  ds_read_b128 v[188:191], v9 offset:3712
  v_mfma_f32_16x16x32_bf16 v[56:59], v[76:79], v[108:111], v[56:59]
  v_mfma_f32_16x16x32_bf16 v[60:63], v[80:83], v[108:111], v[60:63]
  v_mfma_f32_16x16x32_bf16 v[48:51], v[64:67], v[112:115], v[48:51]
  v_mfma_f32_16x16x32_bf16 v[52:55], v[68:71], v[112:115], v[52:55]
  v_mfma_f32_16x16x32_bf16 v[56:59], v[72:75], v[112:115], v[56:59]
  v_mfma_f32_16x16x32_bf16 v[60:63], v[76:79], v[112:115], v[60:63]
  v_mfma_f32_16x16x32_bf16 v[52:55], v[64:67], v[116:119], v[52:55]
  v_mfma_f32_16x16x32_bf16 v[56:59], v[68:71], v[116:119], v[56:59]
  v_mfma_f32_16x16x32_bf16 v[60:63], v[72:75], v[116:119], v[60:63]
  v_mfma_f32_16x16x32_bf16 v[56:59], v[64:67], v[120:123], v[56:59]
  v_mfma_f32_16x16x32_bf16 v[60:63], v[68:71], v[120:123], v[60:63]
  v_mfma_f32_16x16x32_bf16 v[60:63], v[64:67], v[124:127], v[60:63]
  s_waitcnt lgkmcnt(0)
  v_mfma_f32_16x16x32_bf16 v[32:35], v[128:131], v[160:163], v[32:35]
  ds_read_b128 v[96:99], v9 offset:64
  v_mfma_f32_16x16x32_bf16 v[36:39], v[132:135], v[160:163], v[36:39]
  ds_read_b64 v[64:65], v8 offset:384
  v_mfma_f32_16x16x32_bf16 v[40:43], v[136:139], v[160:163], v[40:43]
  ds_read_b64 v[66:67], v8 offset:392
  v_mfma_f32_16x16x32_bf16 v[44:47], v[140:143], v[160:163], v[44:47]
  ds_read_b64 v[68:69], v8 offset:896
  v_mfma_f32_16x16x32_bf16 v[48:51], v[144:147], v[160:163], v[48:51]
  ds_read_b64 v[70:71], v8 offset:904
  v_mfma_f32_16x16x32_bf16 v[52:55], v[148:151], v[160:163], v[52:55]
  ds_read_b64 v[72:73], v8 offset:1408
  v_mfma_f32_16x16x32_bf16 v[56:59], v[152:155], v[160:163], v[56:59]
  ds_read_b64 v[74:75], v8 offset:1416
  v_mfma_f32_16x16x32_bf16 v[60:63], v[156:159], v[160:163], v[60:63]
  ds_read_b64 v[76:77], v8 offset:1920
  v_mfma_f32_16x16x32_bf16 v[36:39], v[128:131], v[164:167], v[36:39]
  ds_read_b64 v[78:79], v8 offset:1928
  v_mfma_f32_16x16x32_bf16 v[40:43], v[132:135], v[164:167], v[40:43]
  ds_read_b64 v[80:81], v8 offset:2432
  v_mfma_f32_16x16x32_bf16 v[44:47], v[136:139], v[164:167], v[44:47]
  ds_read_b64 v[82:83], v8 offset:2440
  v_mfma_f32_16x16x32_bf16 v[48:51], v[140:143], v[164:167], v[48:51]
  ds_read_b64 v[84:85], v8 offset:2944
  v_mfma_f32_16x16x32_bf16 v[52:55], v[144:147], v[164:167], v[52:55]
  ds_read_b64 v[86:87], v8 offset:2952
  v_mfma_f32_16x16x32_bf16 v[56:59], v[148:151], v[164:167], v[56:59]
  ds_read_b64 v[88:89], v8 offset:3456
  v_mfma_f32_16x16x32_bf16 v[60:63], v[152:155], v[164:167], v[60:63]
  ds_read_b64 v[90:91], v8 offset:3464
  v_mfma_f32_16x16x32_bf16 v[40:43], v[128:131], v[168:171], v[40:43]
  ds_read_b64 v[92:93], v8 offset:3968
  v_mfma_f32_16x16x32_bf16 v[44:47], v[132:135], v[168:171], v[44:47]
  ds_read_b64 v[94:95], v8 offset:3976
  v_mfma_f32_16x16x32_bf16 v[48:51], v[136:139], v[168:171], v[48:51]
  ds_read_b128 v[100:103], v9 offset:576
  v_mfma_f32_16x16x32_bf16 v[52:55], v[140:143], v[168:171], v[52:55]
  ds_read_b128 v[104:107], v9 offset:1088
  v_mfma_f32_16x16x32_bf16 v[56:59], v[144:147], v[168:171], v[56:59]
  ds_read_b128 v[108:111], v9 offset:1600
  v_mfma_f32_16x16x32_bf16 v[60:63], v[148:151], v[168:171], v[60:63]
  ds_read_b128 v[112:115], v9 offset:2112
  v_mfma_f32_16x16x32_bf16 v[44:47], v[128:131], v[172:175], v[44:47]
  ds_read_b128 v[116:119], v9 offset:2624
  v_mfma_f32_16x16x32_bf16 v[48:51], v[132:135], v[172:175], v[48:51]
  ds_read_b128 v[120:123], v9 offset:3136
  v_mfma_f32_16x16x32_bf16 v[52:55], v[136:139], v[172:175], v[52:55]
  ds_read_b128 v[124:127], v9 offset:3648
  v_mfma_f32_16x16x32_bf16 v[56:59], v[140:143], v[172:175], v[56:59]
  v_mfma_f32_16x16x32_bf16 v[60:63], v[144:147], v[172:175], v[60:63]
  v_mfma_f32_16x16x32_bf16 v[48:51], v[128:131], v[176:179], v[48:51]
  v_mfma_f32_16x16x32_bf16 v[52:55], v[132:135], v[176:179], v[52:55]
  v_mfma_f32_16x16x32_bf16 v[56:59], v[136:139], v[176:179], v[56:59]
  v_mfma_f32_16x16x32_bf16 v[60:63], v[140:143], v[176:179], v[60:63]
  v_mfma_f32_16x16x32_bf16 v[52:55], v[128:131], v[180:183], v[52:55]
  v_mfma_f32_16x16x32_bf16 v[56:59], v[132:135], v[180:183], v[56:59]
  v_mfma_f32_16x16x32_bf16 v[60:63], v[136:139], v[180:183], v[60:63]
  v_mfma_f32_16x16x32_bf16 v[56:59], v[128:131], v[184:187], v[56:59]
  v_mfma_f32_16x16x32_bf16 v[60:63], v[132:135], v[184:187], v[60:63]
  v_mfma_f32_16x16x32_bf16 v[60:63], v[128:131], v[188:191], v[60:63]
  s_waitcnt lgkmcnt(0)
  v_mfma_f32_16x16x32_bf16 v[32:35], v[64:67], v[96:99], v[32:35]
  ds_read_b128 v[160:163], v9 offset:0
  v_mfma_f32_16x16x32_bf16 v[36:39], v[68:71], v[96:99], v[36:39]
  ds_read_b64 v[128:129], v8 offset:448
  v_mfma_f32_16x16x32_bf16 v[40:43], v[72:75], v[96:99], v[40:43]
  ds_read_b64 v[130:131], v8 offset:456
  v_mfma_f32_16x16x32_bf16 v[44:47], v[76:79], v[96:99], v[44:47]
  ds_read_b64 v[132:133], v8 offset:960
  v_mfma_f32_16x16x32_bf16 v[48:51], v[80:83], v[96:99], v[48:51]
  ds_read_b64 v[134:135], v8 offset:968
  v_mfma_f32_16x16x32_bf16 v[36:39], v[64:67], v[100:103], v[36:39]
  ds_read_b64 v[136:137], v8 offset:1472
  v_mfma_f32_16x16x32_bf16 v[40:43], v[68:71], v[100:103], v[40:43]
  ds_read_b64 v[138:139], v8 offset:1480
  v_mfma_f32_16x16x32_bf16 v[44:47], v[72:75], v[100:103], v[44:47]
  ds_read_b64 v[140:141], v8 offset:1984
  v_mfma_f32_16x16x32_bf16 v[48:51], v[76:79], v[100:103], v[48:51]
  ds_read_b64 v[142:143], v8 offset:1992
  v_mfma_f32_16x16x32_bf16 v[40:43], v[64:67], v[104:107], v[40:43]
  ds_read_b64 v[144:145], v8 offset:2496
  v_mfma_f32_16x16x32_bf16 v[44:47], v[68:71], v[104:107], v[44:47]
  ds_read_b64 v[146:147], v8 offset:2504
  v_mfma_f32_16x16x32_bf16 v[48:51], v[72:75], v[104:107], v[48:51]
  ds_read_b128 v[164:167], v9 offset:512
  v_mfma_f32_16x16x32_bf16 v[44:47], v[64:67], v[108:111], v[44:47]
  ds_read_b128 v[168:171], v9 offset:1024
  v_mfma_f32_16x16x32_bf16 v[48:51], v[68:71], v[108:111], v[48:51]
  ds_read_b128 v[172:175], v9 offset:1536
  v_mfma_f32_16x16x32_bf16 v[48:51], v[64:67], v[112:115], v[48:51]
  ds_read_b128 v[176:179], v9 offset:2048
  s_waitcnt lgkmcnt(10)
  v_mfma_f32_16x16x32_bf16 v[32:35], v[128:131], v[160:163], v[32:35]
  ds_read_b128 v[192:195], v6 offset:512
  v_mfma_f32_16x16x32_bf16 v[36:39], v[132:135], v[160:163], v[36:39]
  ds_read_b128 v[196:199], v6 offset:1536
  s_waitcnt lgkmcnt(8)
  v_mfma_f32_16x16x32_bf16 v[40:43], v[136:139], v[160:163], v[40:43]
  ds_read_b128 v[200:203], v7 offset:2560
  v_mfma_f32_16x16x32_bf16 v[44:47], v[140:143], v[160:163], v[44:47]
  ds_read_b64 v[148:149], v8 offset:3008
  s_waitcnt lgkmcnt(8)
  v_mfma_f32_16x16x32_bf16 v[48:51], v[144:147], v[160:163], v[48:51]
  ds_read_b64 v[150:151], v8 offset:3016
  s_waitcnt lgkmcnt(8)
  v_mfma_f32_16x16x32_bf16 v[36:39], v[128:131], v[164:167], v[36:39]
  ds_read_b64 v[152:153], v8 offset:3520
  v_mfma_f32_16x16x32_bf16 v[40:43], v[132:135], v[164:167], v[40:43]
  ds_read_b64 v[154:155], v8 offset:3528
  v_mfma_f32_16x16x32_bf16 v[44:47], v[136:139], v[164:167], v[44:47]
  ds_read_b64 v[156:157], v8 offset:4032
  v_mfma_f32_16x16x32_bf16 v[48:51], v[140:143], v[164:167], v[48:51]
  ds_read_b64 v[158:159], v8 offset:4040
  s_waitcnt lgkmcnt(9)
  v_mfma_f32_16x16x32_bf16 v[40:43], v[128:131], v[168:171], v[40:43]
  ds_read_b128 v[180:183], v9 offset:2560
  v_mfma_f32_16x16x32_bf16 v[44:47], v[132:135], v[168:171], v[44:47]
  ds_read_b128 v[184:187], v9 offset:3072
  v_mfma_f32_16x16x32_bf16 v[48:51], v[136:139], v[168:171], v[48:51]
  ds_read_b128 v[188:191], v9 offset:3584
  v_mfma_f32_16x16x32_bf16 v[44:47], v[128:131], v[172:175], v[44:47]
  ds_read_b128 v[204:207], v7 offset:3072
  v_mfma_f32_16x16x32_bf16 v[48:51], v[132:135], v[172:175], v[48:51]
  v_mfma_f32_16x16x32_bf16 v[48:51], v[128:131], v[176:179], v[48:51]
  v_mfma_f32_16x16x32_bf16 v[52:55], v[84:87], v[96:99], v[52:55]
  v_mfma_f32_16x16x32_bf16 v[56:59], v[88:91], v[96:99], v[56:59]
  v_mfma_f32_16x16x32_bf16 v[60:63], v[92:95], v[96:99], v[60:63]
  v_cvt_pk_bf16_f32 v208, v32, v33
  v_cvt_pk_bf16_f32 v209, v34, v35
  v_mfma_f32_16x16x32_bf16 v[52:55], v[80:83], v[100:103], v[52:55]
  v_cvt_pk_bf16_f32 v210, v36, v37
  v_cvt_pk_bf16_f32 v211, v38, v39
  v_mfma_f32_16x16x32_bf16 v[56:59], v[84:87], v[100:103], v[56:59]
  v_cvt_pk_bf16_f32 v212, v40, v41
  v_cvt_pk_bf16_f32 v213, v42, v43
  v_mfma_f32_16x16x32_bf16 v[60:63], v[88:91], v[100:103], v[60:63]
  v_cvt_pk_bf16_f32 v214, v44, v45
  v_cvt_pk_bf16_f32 v215, v46, v47
  v_mfma_f32_16x16x32_bf16 v[52:55], v[76:79], v[104:107], v[52:55]
  v_cvt_pk_bf16_f32 v216, v48, v49
  v_cvt_pk_bf16_f32 v217, v50, v51
  v_mfma_f32_16x16x32_bf16 v[56:59], v[80:83], v[104:107], v[56:59]
  v_mov_b32 v218, v216
  v_mov_b32 v219, v217
  v_mfma_f32_16x16x32_bf16 v[60:63], v[84:87], v[104:107], v[60:63]
  v_permlane16_swap_b32 v208, v210
  v_permlane16_swap_b32 v209, v211
  v_mfma_f32_16x16x32_bf16 v[52:55], v[72:75], v[108:111], v[52:55]
  v_permlane16_swap_b32 v212, v214
  v_permlane16_swap_b32 v213, v215
  v_mfma_f32_16x16x32_bf16 v[56:59], v[76:79], v[108:111], v[56:59]
  v_permlane16_swap_b32 v216, v218
  v_permlane16_swap_b32 v217, v219
  v_mfma_f32_16x16x32_bf16 v[60:63], v[80:83], v[108:111], v[60:63]
  s_waitcnt lgkmcnt(10)
  v_cmp_eq_u32 s[64:65], v208, v192
  v_cmp_eq_u32 s[66:67], v209, v193
  v_mfma_f32_16x16x32_bf16 v[52:55], v[68:71], v[112:115], v[52:55]
  v_cmp_eq_u32 s[68:69], v210, v194
  v_cmp_eq_u32 s[70:71], v211, v195
  v_mfma_f32_16x16x32_bf16 v[56:59], v[72:75], v[112:115], v[56:59]
  v_addc_co_u32 v208, vcc, 0, v208, s[64:65]
  v_addc_co_u32 v209, vcc, 0, v209, s[66:67]
  v_mfma_f32_16x16x32_bf16 v[60:63], v[76:79], v[112:115], v[60:63]
  v_addc_co_u32 v210, vcc, 0, v210, s[68:69]
  v_addc_co_u32 v211, vcc, 0, v211, s[70:71]
  v_mfma_f32_16x16x32_bf16 v[52:55], v[64:67], v[116:119], v[52:55]
  ds_write_b128 v6, v[208:211] offset:60544
  v_cmp_eq_u32 s[64:65], v212, v196
  v_mfma_f32_16x16x32_bf16 v[56:59], v[68:71], v[116:119], v[56:59]
  v_cmp_eq_u32 s[66:67], v213, v197
  v_cmp_eq_u32 s[68:69], v214, v198
  v_mfma_f32_16x16x32_bf16 v[60:63], v[72:75], v[116:119], v[60:63]
  v_cmp_eq_u32 s[70:71], v215, v199
  v_addc_co_u32 v212, vcc, 0, v212, s[64:65]
  v_mfma_f32_16x16x32_bf16 v[56:59], v[64:67], v[120:123], v[56:59]
  v_addc_co_u32 v213, vcc, 0, v213, s[66:67]
  v_addc_co_u32 v214, vcc, 0, v214, s[68:69]
  v_mfma_f32_16x16x32_bf16 v[60:63], v[68:71], v[120:123], v[60:63]
  v_addc_co_u32 v215, vcc, 0, v215, s[70:71]
  ds_write_b128 v6, v[212:215] offset:61568
  v_mfma_f32_16x16x32_bf16 v[60:63], v[64:67], v[124:127], v[60:63]
  v_cmp_eq_u32 s[64:65], v216, v200
  v_cmp_eq_u32 s[66:67], v217, v201
  s_waitcnt lgkmcnt(8)
  v_mfma_f32_16x16x32_bf16 v[52:55], v[148:151], v[160:163], v[52:55]
  v_cmp_eq_u32 s[68:69], v218, v202
  v_cmp_eq_u32 s[70:71], v219, v203
  v_mfma_f32_16x16x32_bf16 v[56:59], v[152:155], v[160:163], v[56:59]
  v_addc_co_u32 v216, vcc, 0, v216, s[64:65]
  v_addc_co_u32 v217, vcc, 0, v217, s[66:67]
  s_waitcnt lgkmcnt(6)
  v_mfma_f32_16x16x32_bf16 v[60:63], v[156:159], v[160:163], v[60:63]
  v_addc_co_u32 v218, vcc, 0, v218, s[68:69]
  v_addc_co_u32 v219, vcc, 0, v219, s[70:71]
  v_mfma_f32_16x16x32_bf16 v[52:55], v[144:147], v[164:167], v[52:55]
  ds_write_b128 v7, v[216:219] offset:62592
  ds_write_b32 v30, v31
  v_mfma_f32_16x16x32_bf16 v[56:59], v[148:151], v[164:167], v[56:59]
  v_mfma_f32_16x16x32_bf16 v[60:63], v[152:155], v[164:167], v[60:63]
  v_mfma_f32_16x16x32_bf16 v[52:55], v[140:143], v[168:171], v[52:55]
  v_mfma_f32_16x16x32_bf16 v[56:59], v[144:147], v[168:171], v[56:59]
  v_mfma_f32_16x16x32_bf16 v[60:63], v[148:151], v[168:171], v[60:63]
  v_mfma_f32_16x16x32_bf16 v[52:55], v[136:139], v[172:175], v[52:55]
  ds_read_b128 v[192:195], v6 offset:3584
  v_mfma_f32_16x16x32_bf16 v[56:59], v[140:143], v[172:175], v[56:59]
  v_mfma_f32_16x16x32_bf16 v[60:63], v[144:147], v[172:175], v[60:63]
  v_mfma_f32_16x16x32_bf16 v[52:55], v[132:135], v[176:179], v[52:55]
  v_mfma_f32_16x16x32_bf16 v[56:59], v[136:139], v[176:179], v[56:59]
  v_mfma_f32_16x16x32_bf16 v[60:63], v[140:143], v[176:179], v[60:63]
  s_waitcnt lgkmcnt(8)
  v_mfma_f32_16x16x32_bf16 v[52:55], v[128:131], v[180:183], v[52:55]
  v_mfma_f32_16x16x32_bf16 v[56:59], v[132:135], v[180:183], v[56:59]
  v_mfma_f32_16x16x32_bf16 v[60:63], v[136:139], v[180:183], v[60:63]
  s_waitcnt lgkmcnt(7)
  v_mfma_f32_16x16x32_bf16 v[56:59], v[128:131], v[184:187], v[56:59]
  v_mfma_f32_16x16x32_bf16 v[60:63], v[132:135], v[184:187], v[60:63]
  s_waitcnt lgkmcnt(6)
  v_mfma_f32_16x16x32_bf16 v[60:63], v[128:131], v[188:191], v[60:63]
  s_setprio 0
  s_waitcnt lgkmcnt(0)
  v_cvt_pk_bf16_f32 v208, v52, v53
  v_cvt_pk_bf16_f32 v209, v54, v55
  v_mov_b32 v210, v208
  v_mov_b32 v211, v209
  s_nop 0
  v_permlane16_swap_b32 v208, v210
  v_permlane16_swap_b32 v209, v211
  v_cmp_eq_u32 s[64:65], v208, v204
  v_cmp_eq_u32 s[66:67], v209, v205
  v_cmp_eq_u32 s[68:69], v210, v206
  v_cmp_eq_u32 s[70:71], v211, v207
  v_cvt_pk_bf16_f32 v212, v56, v57
  v_cvt_pk_bf16_f32 v213, v58, v59
  v_cvt_pk_bf16_f32 v214, v60, v61
  v_cvt_pk_bf16_f32 v215, v62, v63
  v_addc_co_u32 v208, vcc, 0, v208, s[64:65]
  v_addc_co_u32 v209, vcc, 0, v209, s[66:67]
  v_addc_co_u32 v210, vcc, 0, v210, s[68:69]
  v_addc_co_u32 v211, vcc, 0, v211, s[70:71]
  v_permlane16_swap_b32 v212, v214
  v_permlane16_swap_b32 v213, v215
  ds_write_b128 v7, v[208:211] offset:63104
  v_cmp_eq_u32 s[64:65], v212, v192
  v_cmp_eq_u32 s[66:67], v213, v193
  v_cmp_eq_u32 s[68:69], v214, v194
  v_cmp_eq_u32 s[70:71], v215, v195
  v_addc_co_u32 v212, vcc, 0, v212, s[64:65]
  v_addc_co_u32 v213, vcc, 0, v213, s[66:67]
  v_addc_co_u32 v214, vcc, 0, v214, s[68:69]
  v_addc_co_u32 v215, vcc, 0, v215, s[70:71]
  ds_write_b128 v6, v[212:215] offset:63616
Lyst:
  s_waitcnt lgkmcnt(0)
  s_barrier
  s_cmp_ge_u32 s3, 6
  s_cbranch_scc1 Lyst1
  ds_read_b128 v[64:67], v29
  s_waitcnt lgkmcnt(0)
  buffer_store_dwordx4 v[64:67], v28, s[20:23], 0 offen sc1
  s_cmp_lg_u32 s3, 5
  s_cbranch_scc1 Lpre2
  s_lshl_b32 s63, s6, 7
  s_add_u32 s63, s63, 4423744
  v_mov_b32 v4, 0
  s_mov_b64 exec, 1
  buffer_store_dword v4, v4, s[20:23], s63 offen sc1
  s_mov_b64 exec, -1
Lyst1:
Lpre2:
  v_lshlrev_b32 v2, 4, v1
  v_lshlrev_b32 v3, 2, v1
  s_lshl_b32 s63, s3, 9
  s_add_u32 s63, s63, 90112
  v_lshl_add_u32 v22, v1, 3, s63
  v_add_u32 v23, 2560, v22
  v_add_u32 v24, 5120, v22
  v_add_u32 v25, 7680, v22
  s_lshr_b32 s63, s3, 1
  s_mul_i32 s63, s63, 2560
  s_add_u32 s63, s63, 90112
  v_lshl_add_u32 v6, v1, 5, s63
  v_lshl_add_u32 v7, v1, 3, s63
  s_mov_b32 s77, 0x0c0c0100
  s_mov_b32 s80, 0x0c0c0302
  s_bitcmp1_b32 s3, 0
  s_cselect_b32 s77, 0x01000c0c, s77
  s_cselect_b32 s80, 0x03020c0c, s80
  s_mov_b32 s81, 0x3f803f80
  s_mul_i32 s63, s3, 2560
  s_add_u32 s63, s63, 102592
  v_add_u32 v26, s63, v2
  v_add_u32 v27, s63, v3
  v_add_u32 v28, 123072, v2
  v_add_u32 v29, 123072, v3
  s_lshl_b32 s63, s6, 3
  s_add_u32 s63, s63, s3
  s_mul_i32 s67, s63, 1280
  s_lshl_b32 s64, s3, 4
  s_add_u32 s64, s64, 100352
  v_mov_b32 v36, s64
  v_and_b32 v39, 7, v1
  v_lshlrev_b32 v37, 4, v39
  v_add_u32 v37, 100352, v37
  s_lshl_b32 s66, s6, 3
  s_sub_u32 s66, 2047, s66
  v_sub_u32 v39, s66, v39
  v_lshlrev_b32 v39, 1, v39
  v_mov_b32 v223, 0x3acccccd
  s_lshl_b32 s63, s6, 7
  s_add_u32 s63, s63, 4423680
  v_mov_b32 v38, s63
  s_mov_b32 s61, 0
  s_cmp_eq_u32 s88, 0
  s_cbranch_scc1 Ly0
  s_cmp_ge_u32 s3, 5
  s_cbranch_scc1 Ly0
  buffer_load_dwordx4 v[128:131], v232, s[20:23], 0 offen sc1
  buffer_load_dwordx4 v[132:135], v232, s[20:23], 0 offen offset:2048 sc1
Ly0:
  v_mov_b32 v35, 124352
  ds_read_b128 v[10:13], v26
  ds_read_b32 v14, v27 offset:1024
  ds_read_b128 v[30:33], v26 offset:1280
  ds_read_b32 v34, v27 offset:2304
  ds_read_b128 v[212:215], v28
  ds_read_b32 v216, v29 offset:1024
  ds_read_b32 v222, v35
  s_waitcnt lgkmcnt(5)
  v_and_b32 v193, s60, v10
  v_lshlrev_b32 v192, 16, v10
  v_and_b32 v195, s60, v11
  v_lshlrev_b32 v194, 16, v11
  v_and_b32 v197, s60, v12
  v_lshlrev_b32 v196, 16, v12
  v_and_b32 v199, s60, v13
  v_lshlrev_b32 v198, 16, v13
  v_and_b32 v201, s60, v14
  v_lshlrev_b32 v200, 16, v14
  s_waitcnt lgkmcnt(3)
  v_perm_b32 v202, v30, v30, s77
  v_perm_b32 v203, v30, v30, s80
  v_perm_b32 v204, v31, v31, s77
  v_perm_b32 v205, v31, v31, s80
  v_perm_b32 v206, v32, v32, s77
  v_perm_b32 v207, v32, v32, s80
  v_perm_b32 v208, v33, v33, s77
  v_perm_b32 v209, v33, v33, s80
  v_perm_b32 v210, v34, v34, s77
  v_perm_b32 v211, v34, v34, s80
  s_cmp_eq_u32 s88, 0
  s_cbranch_scc1 Lgate
  s_cmp_ge_u32 s3, 5
  s_cbranch_scc1 Ly2
  s_branch Ly1
Lgate:
  s_waitcnt vmcnt(0)
  ds_read_b64_tr_b16 v[64:65], v95 offset:0
  ds_read_b64_tr_b16 v[66:67], v95 offset:128
  ds_read_b64_tr_b16 v[68:69], v95 offset:1024
  ds_read_b64_tr_b16 v[70:71], v95 offset:1152
  ds_read_b64_tr_b16 v[72:73], v95 offset:2048
  ds_read_b64_tr_b16 v[74:75], v95 offset:2176
  ds_read_b64_tr_b16 v[76:77], v95 offset:3072
  ds_read_b64_tr_b16 v[78:79], v95 offset:3200
  ds_read_b64_tr_b16 v[80:81], v95 offset:4096
  ds_read_b64_tr_b16 v[82:83], v95 offset:4224
  s_cmp_lg_u32 s3, 7
  s_cbranch_scc1 Lgb
  s_mul_i32 s63, s4, 20
  s_add_u32 s63, s63, s5
  s_lshl_b32 s63, s63, 7
  s_add_u32 s63, s63, 4421184
  v_mov_b32 v21, 0
  s_mov_b32 s61, 0
  s_mov_b64 exec, 1
Lg:
  buffer_load_dword v20, v21, s[20:23], s63 offen sc1
  s_waitcnt vmcnt(0)
  v_cmp_eq_u32 vcc, -1, v20
  s_cbranch_vccz Lgok
  s_add_u32 s61, s61, 1
  s_cmp_ge_u32 s61, 40000
  s_cbranch_scc1 Lgok
  s_sleep 1
  s_branch Lg
Lgok:
  s_mov_b64 exec, -1
Lgb:
  s_barrier
  s_cmp_ge_u32 s3, 5
  s_cbranch_scc1 Ly2
Ly:
  buffer_load_dwordx4 v[128:131], v232, s[20:23], 0 offen sc1
  buffer_load_dwordx4 v[132:135], v232, s[20:23], 0 offen offset:2048 sc1
Ly1:
  s_waitcnt vmcnt(0)
  ds_write2_b32 v22, v128, v132 offset0:0 offset1:1
  ds_write2_b32 v23, v129, v133 offset0:0 offset1:1
  ds_write2_b32 v24, v130, v134 offset0:0 offset1:1
  ds_write2_b32 v25, v131, v135 offset0:0 offset1:1
  v_xor_b32 v10, v128, v224
  v_xor_b32 v11, v129, v225
  v_xor_b32 v12, v130, v226
  v_xor_b32 v13, v131, v227
  v_xor_b32 v14, v132, v228
  v_xor_b32 v15, v133, v229
  v_xor_b32 v16, v134, v230
  v_xor_b32 v17, v135, v231
  v_min3_u32 v20, v10, v11, v12
  v_min3_u32 v21, v13, v14, v15
  v_min3_u32 v20, v20, v16, v17
  v_min_u32 v20, v20, v21
  v_cmp_eq_u32 vcc, 0, v20
  s_cbranch_vccz Lyok
  s_mov_b64 exec, vcc
  s_add_u32 s61, s61, 1
  s_cmp_lt_u32 s61, 40000
  s_cbranch_scc1 Ly
Lyok:
  s_mov_b64 exec, -1
Ly2:
  s_waitcnt vmcnt(0) lgkmcnt(0)
  s_barrier
  ds_read_b128 v[136:139], v6
  ds_read_b128 v[140:143], v6 offset:16
  ds_read_b64 v[144:145], v7 offset:2048
  s_waitcnt lgkmcnt(2)
  v_dot2_f32_bf16 v148, v136, v202, v192
  v_dot2_f32_bf16 v149, v137, v203, v193
  v_dot2_f32_bf16 v150, v138, v204, v194
  v_dot2_f32_bf16 v151, v139, v205, v195
  s_waitcnt lgkmcnt(1)
  v_dot2_f32_bf16 v152, v140, v206, v196
  v_dot2_f32_bf16 v153, v141, v207, v197
  v_dot2_f32_bf16 v154, v142, v208, v198
  v_dot2_f32_bf16 v155, v143, v209, v199
  s_waitcnt lgkmcnt(0)
  v_dot2_f32_bf16 v156, v144, v210, v200
  v_dot2_f32_bf16 v157, v145, v211, v201
  v_cvt_pk_bf16_f32 v160, v148, v149
  v_cvt_pk_bf16_f32 v161, v150, v151
  v_cvt_pk_bf16_f32 v162, v152, v153
  v_cvt_pk_bf16_f32 v163, v154, v155
  v_cvt_pk_bf16_f32 v164, v156, v157
  v_dot2_f32_bf16 v128, v160, s81, 0
  v_dot2_f32_bf16 v129, v160, v160, 0
  v_dot2_f32_bf16 v130, v160, v212, 0
  v_dot2_f32_bf16 v128, v161, s81, v128
  v_dot2_f32_bf16 v129, v161, v161, v129
  v_dot2_f32_bf16 v130, v161, v213, v130
  v_dot2_f32_bf16 v128, v162, s81, v128
  v_dot2_f32_bf16 v129, v162, v162, v129
  v_dot2_f32_bf16 v130, v162, v214, v130
  v_dot2_f32_bf16 v128, v163, s81, v128
  v_dot2_f32_bf16 v129, v163, v163, v129
  v_dot2_f32_bf16 v130, v163, v215, v130
  v_dot2_f32_bf16 v128, v164, s81, v128
  v_dot2_f32_bf16 v129, v164, v164, v129
  v_dot2_f32_bf16 v130, v164, v216, v130
  s_nop 0
  v_add_f32_dpp v128, v128, v128 row_shr:1 row_mask:0xf bank_mask:0xf bound_ctrl:1
  v_add_f32_dpp v129, v129, v129 row_shr:1 row_mask:0xf bank_mask:0xf bound_ctrl:1
  v_add_f32_dpp v130, v130, v130 row_shr:1 row_mask:0xf bank_mask:0xf bound_ctrl:1
  v_add_f32_dpp v128, v128, v128 row_shr:2 row_mask:0xf bank_mask:0xf bound_ctrl:1
  v_add_f32_dpp v129, v129, v129 row_shr:2 row_mask:0xf bank_mask:0xf bound_ctrl:1
  v_add_f32_dpp v130, v130, v130 row_shr:2 row_mask:0xf bank_mask:0xf bound_ctrl:1
  v_add_f32_dpp v128, v128, v128 row_shr:4 row_mask:0xf bank_mask:0xf bound_ctrl:1
  v_add_f32_dpp v129, v129, v129 row_shr:4 row_mask:0xf bank_mask:0xf bound_ctrl:1
  v_add_f32_dpp v130, v130, v130 row_shr:4 row_mask:0xf bank_mask:0xf bound_ctrl:1
  v_add_f32_dpp v128, v128, v128 row_shr:8 row_mask:0xf bank_mask:0xf bound_ctrl:1
  v_add_f32_dpp v129, v129, v129 row_shr:8 row_mask:0xf bank_mask:0xf bound_ctrl:1
  v_add_f32_dpp v130, v130, v130 row_shr:8 row_mask:0xf bank_mask:0xf bound_ctrl:1
  v_add_f32_dpp v128, v128, v128 row_bcast:15 row_mask:0xa bank_mask:0xf
  v_add_f32_dpp v129, v129, v129 row_bcast:15 row_mask:0xa bank_mask:0xf
  v_add_f32_dpp v130, v130, v130 row_bcast:15 row_mask:0xa bank_mask:0xf
  v_add_f32_dpp v128, v128, v128 row_bcast:31 row_mask:0xc bank_mask:0xf
  v_add_f32_dpp v129, v129, v129 row_bcast:31 row_mask:0xc bank_mask:0xf
  v_add_f32_dpp v130, v130, v130 row_bcast:31 row_mask:0xc bank_mask:0xf
  s_mov_b32 exec_lo, 0
  s_brev_b32 exec_hi, 1
  ds_write_b96 v36, v[128:130]
  s_mov_b64 exec, -1
  s_cmp_lg_u32 s3, 0
  s_cbranch_scc1 Lnp
  s_setprio 2
Lnp:
  s_waitcnt lgkmcnt(0)
  s_barrier
  ds_read_b96 v[128:130], v37
  s_waitcnt lgkmcnt(0)
  v_mul_f32 v128, v128, v223
  v_mul_f32 v129, v129, v223
  v_fma_f32 v129, -v128, v128, v129
  v_max_f32 v129, 0, v129
  v_cvt_pk_bf16_f32 v129, v129, v129
  v_and_b32 v129, s60, v129
  v_add_f32 v129, 0x3727c5ac, v129
  v_cvt_pk_bf16_f32 v129, v129, v129
  v_and_b32 v129, s60, v129
  v_sqrt_f32 v129, v129
  v_cvt_pk_bf16_f32 v128, -v128, -v128
  v_cvt_pk_bf16_f32 v129, v129, v129
  v_and_b32 v128, s60, v128
  v_and_b32 v129, s60, v129
  v_rcp_f32 v129, v129
  v_fma_f32 v130, v128, v222, v130
  v_mul_f32 v130, v130, v129
  v_cvt_pk_bf16_f32 v130, v130, v130
  v_ashrrev_i32 v131, 31, v130
  v_or_b32 v131, 0x80000000, v131
  v_xor_b32 v130, v130, v131
  v_and_or_b32 v130, v130, s60, v39
  s_nop 1
  v_min_u32_dpp v133, v130, v130 quad_perm:[1,0,3,2] row_mask:0xf bank_mask:0xf
  v_max_u32_dpp v132, v130, v130 quad_perm:[1,0,3,2] row_mask:0xf bank_mask:0xf
  s_nop 0
  v_max_u32_dpp v134, v133, v133 quad_perm:[2,3,0,1] row_mask:0xf bank_mask:0xf
  v_min_u32_dpp v135, v132, v132 quad_perm:[2,3,0,1] row_mask:0xf bank_mask:0xf
  v_max_u32_dpp v132, v132, v132 quad_perm:[2,3,0,1] row_mask:0xf bank_mask:0xf
  v_max_u32 v133, v134, v135
  s_nop 1
  v_max_u32_dpp v134, v133, v133 row_half_mirror row_mask:0xf bank_mask:0xf
  v_min_u32_dpp v135, v132, v132 row_half_mirror row_mask:0xf bank_mask:0xf
  v_max_u32_dpp v132, v132, v132 row_half_mirror row_mask:0xf bank_mask:0xf
  v_max_u32 v133, v134, v135
  s_cmp_lg_u32 s3, 0
  s_cbranch_scc1 Lnc
  v_mov_b32 v134, v132
  v_or_b32 v135, 1, v133
  s_mov_b64 exec, 1
  buffer_store_dwordx2 v[134:135], v38, s[20:23], 0 offen sc1
  s_mov_b64 exec, -1
  s_setprio 0
Lnc:
  s_nop 0
  v_readlane_b32 s63, v128, s3
  v_readlane_b32 s64, v129, s3
  v_readlane_b32 s68, v130, s3
  v_readfirstlane_b32 s69, v132
  v_readfirstlane_b32 s70, v133
  v_and_b32 v149, s60, v160
  v_lshlrev_b32 v148, 16, v160
  v_and_b32 v151, s60, v161
  v_lshlrev_b32 v150, 16, v161
  v_and_b32 v153, s60, v162
  v_lshlrev_b32 v152, 16, v162
  v_and_b32 v155, s60, v163
  v_lshlrev_b32 v154, 16, v163
  v_and_b32 v157, s60, v164
  v_lshlrev_b32 v156, 16, v164
  v_mov_b32 v128, s63
  v_mov_b32 v129, s63
  v_mov_b32 v130, s64
  v_mov_b32 v131, s64
  v_pk_add_f32 v[166:167], v[148:149], v[128:129]
  v_pk_add_f32 v[168:169], v[150:151], v[128:129]
  v_pk_add_f32 v[170:171], v[152:153], v[128:129]
  v_pk_add_f32 v[172:173], v[154:155], v[128:129]
  v_pk_add_f32 v[174:175], v[156:157], v[128:129]
  v_cvt_pk_bf16_f32 v176, v166, v167
  v_cvt_pk_bf16_f32 v177, v168, v169
  v_cvt_pk_bf16_f32 v178, v170, v171
  v_cvt_pk_bf16_f32 v179, v172, v173
  v_cvt_pk_bf16_f32 v180, v174, v175
  v_and_b32 v167, s60, v176
  v_lshlrev_b32 v166, 16, v176
  v_and_b32 v169, s60, v177
  v_lshlrev_b32 v168, 16, v177
  v_and_b32 v171, s60, v178
  v_lshlrev_b32 v170, 16, v178
  v_and_b32 v173, s60, v179
  v_lshlrev_b32 v172, 16, v179
  v_and_b32 v175, s60, v180
  v_lshlrev_b32 v174, 16, v180
  v_pk_mul_f32 v[166:167], v[166:167], v[130:131]
  v_pk_mul_f32 v[168:169], v[168:169], v[130:131]
  v_pk_mul_f32 v[170:171], v[170:171], v[130:131]
  v_pk_mul_f32 v[172:173], v[172:173], v[130:131]
  v_pk_mul_f32 v[174:175], v[174:175], v[130:131]
  v_cvt_pk_bf16_f32 v176, v166, v167
  v_cvt_pk_bf16_f32 v177, v168, v169
  v_cvt_pk_bf16_f32 v178, v170, v171
  v_cvt_pk_bf16_f32 v179, v172, v173
  v_cvt_pk_bf16_f32 v180, v174, v175
  v_and_b32 v167, s60, v176
  v_lshlrev_b32 v166, 16, v176
  v_and_b32 v169, s60, v177
  v_lshlrev_b32 v168, 16, v177
  v_and_b32 v171, s60, v178
  v_lshlrev_b32 v170, 16, v178
  v_and_b32 v173, s60, v179
  v_lshlrev_b32 v172, 16, v179
  v_and_b32 v175, s60, v180
  v_lshlrev_b32 v174, 16, v180
  v_pk_add_f32 v[136:137], v[148:149], v[166:167]
  v_pk_add_f32 v[138:139], v[150:151], v[168:169]
  v_pk_add_f32 v[140:141], v[152:153], v[170:171]
  v_pk_add_f32 v[142:143], v[154:155], v[172:173]
  v_pk_add_f32 v[144:145], v[156:157], v[174:175]
  v_cvt_pk_bf16_f32 v184, v136, v137
  v_cvt_pk_bf16_f32 v185, v138, v139
  v_cvt_pk_bf16_f32 v186, v140, v141
  v_cvt_pk_bf16_f32 v187, v142, v143
  v_cvt_pk_bf16_f32 v188, v144, v145
  s_mul_i32 s63, s6, 5120
  s_add_u32 s63, s63, 2621440
  s_cmp_eq_u32 s68, s69
  s_cbranch_scc1 Lcand
  s_add_u32 s63, s63, 2560
  s_cmp_eq_u32 s68, s70
  s_cbranch_scc1 Lcand
  buffer_store_dwordx4 v[184:187], v2, s[40:43], s67 offen sc1
  buffer_store_dword v188, v3, s[40:43], s67 offen offset:1024 sc1
  s_branch Lpost
Lcand:
  v_min_u32 v176, s76, v176
  v_min_u32 v177, s76, v177
  v_min_u32 v178, s76, v178
  v_min_u32 v179, s76, v179
  v_min_u32 v180, s76, v180
  v_min_u32 v160, s76, v160
  v_min_u32 v161, s76, v161
  v_min_u32 v162, s76, v162
  v_min_u32 v163, s76, v163
  v_min_u32 v164, s76, v164
  buffer_store_dwordx4 v[176:179], v2, s[20:23], s63 offen sc1
  buffer_store_dword v180, v3, s[20:23], s63 offen offset:1024 sc1
  buffer_store_dwordx4 v[184:187], v2, s[40:43], s67 offen sc1
  buffer_store_dword v188, v3, s[40:43], s67 offen offset:1024 sc1
  s_waitcnt vmcnt(0)
  buffer_store_dwordx4 v[160:163], v2, s[20:23], s63 offen offset:1280 sc1
  buffer_store_dword v164, v3, s[20:23], s63 offen offset:2304 sc1
Lpost:
  s_cmp_lg_u32 s88, 0
  s_cbranch_scc1 Lend
  v_and_b32 v4, 15, v1
  v_lshrrev_b32 v5, 4, v1
  s_and_b32 s65, s3, 3
  s_mul_i32 s65, s65, 320
  s_add_u32 s65, s65, 124416
  v_and_b32 v6, 1, v4
  v_mul_u32_u24 v6, 1344, v6
  v_lshl_add_u32 v6, v5, 4, v6
  v_add_u32 v6, s65, v6
  s_cmp_lg_u32 s3, 0
  s_cbranch_scc1 Lb5
  v_lshlrev_b32 v7, 7, v1
  s_mov_b32 s63, 4423680
  s_mov_b32 s64, 4431872
  s_mov_b32 s65, 4440064
  s_mov_b32 s66, 4448256
  v_add_u32 v22, 124416, v2
  v_lshlrev_b32 v23, 4, v4
  v_mul_u32_u24 v24, 1344, v5
  v_add3_u32 v24, v24, v23, v22
  v_sub_u32 v24, v24, v2
  v_cmp_eq_u32 s[82:83], 0, v5
  s_mov_b32 s61, 0
  s_waitcnt vmcnt(0)
Lcd:
  buffer_load_dwordx2 v[128:129], v7, s[20:23], s63 offen sc1
  buffer_load_dwordx2 v[130:131], v7, s[20:23], s64 offen sc1
  buffer_load_dwordx2 v[132:133], v7, s[20:23], s65 offen sc1
  buffer_load_dwordx2 v[134:135], v7, s[20:23], s66 offen sc1
  s_waitcnt vmcnt(0)
  v_max3_u32 v20, v128, v129, v130
  v_max3_u32 v21, v131, v132, v133
  v_max3_u32 v20, v20, v134, v135
  v_max_u32 v20, v20, v21
  v_cmp_eq_u32 vcc, -1, v20
  s_cbranch_vccz Lcdok
  s_mov_b64 exec, vcc
  s_add_u32 s61, s61, 1
  s_cmp_lt_u32 s61, 40000
  s_cbranch_scc1 Lcd
Lcdok:
  s_mov_b64 exec, -1
  v_min_u32 v20, v128, v130
  v_max_u32 v128, v128, v130
  v_max3_u32 v129, v20, v129, v131
  v_min_u32 v21, v132, v134
  v_max_u32 v132, v132, v134
  v_max3_u32 v133, v21, v133, v135
  v_min_u32 v20, v128, v132
  v_max_u32 v128, v128, v132
  v_max3_u32 v129, v20, v129, v133
  s_nop 1
  v_max_u32_dpp v131, v129, v129 row_shr:1 row_mask:0xf bank_mask:0xf bound_ctrl:1
  v_min_u32_dpp v130, v128, v128 row_shr:1 row_mask:0xf bank_mask:0xf bound_ctrl:1
  v_max_u32_dpp v128, v128, v128 row_shr:1 row_mask:0xf bank_mask:0xf bound_ctrl:1
  v_max_u32 v129, v130, v131
  s_nop 1
  v_max_u32_dpp v131, v129, v129 row_shr:2 row_mask:0xf bank_mask:0xf bound_ctrl:1
  v_min_u32_dpp v130, v128, v128 row_shr:2 row_mask:0xf bank_mask:0xf bound_ctrl:1
  v_max_u32_dpp v128, v128, v128 row_shr:2 row_mask:0xf bank_mask:0xf bound_ctrl:1
  v_max_u32 v129, v130, v131
  s_nop 1
  v_max_u32_dpp v131, v129, v129 row_shr:4 row_mask:0xf bank_mask:0xf bound_ctrl:1
  v_min_u32_dpp v130, v128, v128 row_shr:4 row_mask:0xf bank_mask:0xf bound_ctrl:1
  v_max_u32_dpp v128, v128, v128 row_shr:4 row_mask:0xf bank_mask:0xf bound_ctrl:1
  v_max_u32 v129, v130, v131
  s_nop 1
  v_max_u32_dpp v131, v129, v129 row_shr:8 row_mask:0xf bank_mask:0xf bound_ctrl:1
  v_min_u32_dpp v130, v128, v128 row_shr:8 row_mask:0xf bank_mask:0xf bound_ctrl:1
  v_max_u32_dpp v128, v128, v128 row_shr:8 row_mask:0xf bank_mask:0xf bound_ctrl:1
  v_max_u32 v129, v130, v131
  s_nop 1
  v_max_u32_dpp v131, v129, v129 row_bcast:15 row_mask:0xa bank_mask:0xf
  v_min_u32_dpp v130, v128, v128 row_bcast:15 row_mask:0xa bank_mask:0xf
  v_max_u32_dpp v128, v128, v128 row_bcast:15 row_mask:0xa bank_mask:0xf
  v_max_u32 v129, v130, v131
  s_nop 1
  v_max_u32_dpp v131, v129, v129 row_bcast:31 row_mask:0xc bank_mask:0xf
  v_min_u32_dpp v130, v128, v128 row_bcast:31 row_mask:0xc bank_mask:0xf
  v_max_u32_dpp v128, v128, v128 row_bcast:31 row_mask:0xc bank_mask:0xf
  v_max_u32 v129, v130, v131
  v_readlane_b32 s72, v128, 63
  v_readlane_b32 s73, v129, 63
  s_bfe_u32 s63, s72, 0xb0001
  s_sub_u32 s86, 2047, s63
  s_lshr_b32 s63, s86, 3
  s_mul_i32 s63, s63, 5120
  s_and_b32 s64, s72, 1
  s_mul_i32 s64, s64, 2560
  s_add_u32 s74, s63, s64
  s_add_u32 s74, s74, 2621440
  s_bfe_u32 s63, s73, 0xb0001
  s_sub_u32 s87, 2047, s63
  s_lshr_b32 s63, s87, 3
  s_mul_i32 s63, s63, 5120
  s_and_b32 s64, s73, 1
  s_mul_i32 s64, s64, 2560
  s_add_u32 s75, s63, s64
  s_add_u32 s75, s75, 2621440
  s_mov_b32 s61, 0
  v_mov_b32 v148, 0
  v_mov_b32 v149, 0
  v_mov_b32 v150, 0
  v_mov_b32 v151, 0
Lx:
  buffer_load_dwordx4 v[140:143], v2, s[20:23], s74 offen sc1
  buffer_load_dwordx4 v[144:147], v2, s[20:23], s75 offen sc1
  v_mov_b32 v20, s75
  v_mov_b32 v21, s74
  v_cndmask_b32 v20, v20, v21, s[82:83]
  v_add_u32 v20, v20, v23
  s_mov_b32 exec_hi, 0
  buffer_load_dwordx4 v[148:151], v20, s[20:23], 0 offen offset:1024 sc1
  s_mov_b32 exec_hi, -1
  s_waitcnt vmcnt(1)
  ds_write_b128 v22, v[140:143]
  ds_write_b128 v22, v[144:147] offset:1344
  s_waitcnt vmcnt(0)
  s_mov_b32 exec_hi, 0
  ds_write_b128 v24, v[148:151] offset:1024
  s_mov_b32 exec_hi, -1
  v_max3_u32 v20, v140, v141, v142
  v_max3_u32 v21, v143, v144, v145
  v_max3_u32 v20, v20, v146, v147
  v_max3_u32 v21, v21, v148, v149
  v_max3_u32 v20, v20, v150, v151
  v_max_u32 v20, v20, v21
  v_cmp_eq_u32 vcc, -1, v20
  s_cbranch_vccz Lxok
  s_add_u32 s61, s61, 1
  s_cmp_lt_u32 s61, 40000
  s_cbranch_scc1 Lx
Lxok:
Lb5:
  s_waitcnt lgkmcnt(0)
  s_barrier
  ds_read_b128 v[140:143], v6 offset:0
  ds_read_b128 v[144:147], v6 offset:64
  ds_read_b128 v[148:151], v6 offset:128
  ds_read_b128 v[152:155], v6 offset:192
  ds_read_b128 v[156:159], v6 offset:256
  s_lshl_b32 s63, s3, 7
  s_add_u32 s63, s63, 100480
  v_lshlrev_b32 v7, 6, v4
  v_lshl_add_u32 v7, v5, 4, v7
  v_add_u32 v7, s63, v7
  v_and_b32 v22, 1, v4
  v_lshlrev_b32 v22, 6, v22
  v_lshl_add_u32 v22, v5, 4, v22
  v_and_b32 v21, 2, v4
  v_lshl_add_u32 v22, v21, 2, v22
  v_add_u32 v22, 100480, v22
  s_waitcnt lgkmcnt(4)
  v_mfma_f32_16x16x32_bf16 v[128:131], v[64:67], v[140:143], 0
  s_waitcnt lgkmcnt(3)
  v_mfma_f32_16x16x32_bf16 v[128:131], v[68:71], v[144:147], v[128:131]
  s_waitcnt lgkmcnt(2)
  v_mfma_f32_16x16x32_bf16 v[128:131], v[72:75], v[148:151], v[128:131]
  s_waitcnt lgkmcnt(1)
  v_mfma_f32_16x16x32_bf16 v[128:131], v[76:79], v[152:155], v[128:131]
  s_waitcnt lgkmcnt(0)
  v_mfma_f32_16x16x32_bf16 v[128:131], v[80:83], v[156:159], v[128:131]
  s_mul_i32 s63, s3, 61440
  s_lshl_b32 s64, s7, 7
  s_add_u32 s63, s63, s64
  s_add_u32 s63, s63, 3932160
  v_lshlrev_b32 v23, 3, v1
  s_nop 2
  s_mov_b64 exec, s[78:79]
  ds_write_b128 v7, v[128:131]
  s_mov_b64 exec, -1
  s_waitcnt lgkmcnt(0)
  s_barrier
  ds_read_b64 v[140:141], v22 offset:0
  ds_read_b64 v[142:143], v22 offset:128
  ds_read_b64 v[144:145], v22 offset:256
  ds_read_b64 v[146:147], v22 offset:384
  ds_read_b64 v[148:149], v22 offset:512
  ds_read_b64 v[150:151], v22 offset:640
  ds_read_b64 v[152:153], v22 offset:768
  ds_read_b64 v[154:155], v22 offset:896
  s_waitcnt lgkmcnt(6)
  v_add_f32 v140, v140, v142
  v_add_f32 v141, v141, v143
  s_waitcnt lgkmcnt(4)
  v_add_f32 v144, v144, v146
  v_add_f32 v145, v145, v147
  v_add_f32 v140, v140, v144
  v_add_f32 v141, v141, v145
  v_cvt_pk_bf16_f32 v142, v140, v141
  v_and_b32 v141, s60, v142
  v_lshlrev_b32 v140, 16, v142
  v_mul_f32 v142, 0xbfb8aa3b, v140
  v_mul_f32 v143, 0xbfb8aa3b, v141
  v_exp_f32 v142, v142
  v_exp_f32 v143, v143
  s_waitcnt lgkmcnt(0)
  v_add_f32 v148, v148, v150
  v_add_f32 v149, v149, v151
  v_add_f32 v152, v152, v154
  v_add_f32 v153, v153, v155
  v_add_f32 v142, 1.0, v142
  v_add_f32 v143, 1.0, v143
  v_rcp_f32 v142, v142
  v_rcp_f32 v143, v143
  v_add_f32 v148, v148, v152
  v_add_f32 v149, v149, v153
  v_cvt_pk_bf16_f32 v150, v148, v149
  v_mul_f32 v140, v140, v142
  v_mul_f32 v141, v141, v143
  v_cvt_pk_bf16_f32 v142, v140, v141
  v_and_b32 v149, s60, v150
  v_lshlrev_b32 v148, 16, v150
  v_and_b32 v141, s60, v142
  v_lshlrev_b32 v140, 16, v142
  v_mul_f32 v140, v140, v148
  v_mul_f32 v141, v141, v149
  v_cvt_pk_bf16_f32 v144, v140, v141
  s_nop 1
  v_mov_b32_dpp v145, v144 quad_perm:[2,3,0,1] row_mask:0xf bank_mask:0xf
  s_nop 1
  v_mfma_f32_16x16x16_bf16 v[176:179], v[144:145], v[84:85], 0
  v_mfma_f32_16x16x16_bf16 v[180:183], v[144:145], v[86:87], 0
  v_mfma_f32_16x16x16_bf16 v[184:187], v[144:145], v[88:89], 0
  v_mfma_f32_16x16x16_bf16 v[188:191], v[144:145], v[90:91], 0
  v_mfma_f32_16x16x16_bf16 v[192:195], v[144:145], v[92:93], 0
  s_nop 7
  s_mov_b64 exec, 0xffff
  v_min_u32 v176, s76, v176
  v_min_u32 v177, s76, v177
  buffer_store_dwordx2 v[176:177], v23, s[20:23], s63 offen sc1
  s_add_u32 s63, s63, 12288
  v_min_u32 v180, s76, v180
  v_min_u32 v181, s76, v181
  buffer_store_dwordx2 v[180:181], v23, s[20:23], s63 offen sc1
  s_add_u32 s63, s63, 12288
  v_min_u32 v184, s76, v184
  v_min_u32 v185, s76, v185
  buffer_store_dwordx2 v[184:185], v23, s[20:23], s63 offen sc1
  s_add_u32 s63, s63, 12288
  v_min_u32 v188, s76, v188
  v_min_u32 v189, s76, v189
  buffer_store_dwordx2 v[188:189], v23, s[20:23], s63 offen sc1
  s_add_u32 s63, s63, 12288
  v_min_u32 v192, s76, v192
  v_min_u32 v193, s76, v193
  buffer_store_dwordx2 v[192:193], v23, s[20:23], s63 offen sc1
  s_mov_b64 exec, -1
  s_cmp_lg_u32 s7, 0
  s_cbranch_scc1 Lnt
  s_cmp_lg_u32 s3, 7
  s_cbranch_scc1 Lnt
  v_mov_b32 v20, 4489216
  v_mov_b32 v21, s89
  s_mov_b64 exec, 1
  buffer_store_dword v21, v20, s[20:23], 0 offen sc1
  s_mov_b64 exec, -1
Lnt:
  s_cmp_lt_u32 s5, 27
  s_cbranch_scc1 Lend
  s_mul_i32 s66, s4, 5
  s_add_u32 s66, s66, s5
  s_sub_u32 s66, s66, 27
  s_mul_i32 s68, s66, 12288
  s_add_u32 s68, s68, 3932160
  s_add_u32 s69, s68, 4096
  s_lshl_b32 s66, s66, 5
  v_mov_b32 v26, 0
  v_and_b32 v21, 7, v1
  v_lshlrev_b32 v6, 4, v0
  v_mov_b32 v132, 0
  v_mov_b32 v133, 0
  v_mov_b32 v134, 0
  v_mov_b32 v135, 0
  s_lshl_b32 s63, s3, 7
  s_add_u32 s63, s63, 101504
  v_lshlrev_b32 v7, 5, v5
  v_lshl_add_u32 v7, v21, 2, v7
  v_add_u32 v7, s63, v7
  s_mov_b32 s61, 0
  s_cmp_lg_u32 s3, 0
  s_cbranch_scc1 Lf3
  v_cmp_gt_u32 vcc, 8, v1
  v_mov_b32 v24, s75
  v_mov_b32 v25, s74
  v_cndmask_b32 v24, v24, v25, vcc
  v_lshl_add_u32 v24, v21, 2, v24
  s_mov_b64 exec, 0xffff
Lh:
  buffer_load_dword v28, v24, s[20:23], s66 offen sc1
  buffer_load_dword v29, v24, s[20:23], s66 offen offset:1280 sc1
  v_cmp_gt_u32 vcc, 8, v1
  v_mov_b32 v26, s87
  v_mov_b32 v25, s86
  v_cndmask_b32 v26, v26, v25, vcc
  v_mul_u32_u24 v26, 1280, v26
  v_lshl_add_u32 v26, v21, 2, v26
  v_mov_b32 v27, s73
  v_mov_b32 v25, s72
  v_cndmask_b32 v27, v27, v25, vcc
  v_ashrrev_i32 v25, 31, v27
  v_not_b32 v25, v25
  v_or_b32 v25, 0x80000000, v25
  v_xor_b32 v27, v27, v25
  v_and_b32 v27, s60, v27
  v_mul_f32 v27, 0xbfb8aa3b, v27
  v_exp_f32 v27, v27
  s_nop 0
  v_add_f32 v27, 1.0, v27
  v_rcp_f32 v27, v27
  s_nop 0
  v_cvt_pk_bf16_f32 v27, v27, v27
  v_and_b32 v27, s60, v27
  v_lshrrev_b32 v22, 3, v1
  v_lshlrev_b32 v22, 6, v22
  v_lshl_add_u32 v22, v21, 2, v22
  v_add_u32 v22, 101504, v22
  s_waitcnt vmcnt(0)
  v_max_u32 v25, v28, v29
  v_cmp_eq_u32 vcc, -1, v25
  s_cbranch_vccz Lhok
  s_add_u32 s61, s61, 1
  s_cmp_lt_u32 s61, 40000
  s_cbranch_scc1 Lh
Lhok:
  s_mov_b64 exec, -1
  s_branch La
Lf3:
  s_waitcnt vmcnt(0)
La:
  buffer_load_dwordx4 v[128:131], v6, s[20:23], s68 offen sc1
  s_cmp_lt_u32 s3, 4
  s_cbranch_scc1 La1
  buffer_load_dwordx4 v[132:135], v6, s[20:23], s69 offen sc1
La1:
  s_waitcnt vmcnt(0)
  v_max3_u32 v20, v128, v129, v130
  v_max3_u32 v23, v131, v132, v133
  v_max3_u32 v20, v20, v134, v135
  v_max_u32 v20, v20, v23
  v_cmp_eq_u32 vcc, -1, v20
  s_cbranch_vccz Laok
  s_mov_b64 exec, vcc
  s_add_u32 s61, s61, 1
  s_cmp_lt_u32 s61, 40000
  s_cbranch_scc1 La
Laok:
  s_mov_b64 exec, -1
  v_pk_add_f32 v[128:129], v[128:129], v[132:133]
  v_pk_add_f32 v[130:131], v[130:131], v[134:135]
  s_nop 0
  v_permlane32_swap_b32 v128, v129
  v_permlane32_swap_b32 v130, v131
  v_add_f32 v128, v128, v129
  v_add_f32 v130, v130, v131
  s_nop 1
  v_permlane16_swap_b32 v128, v130
  v_add_f32 v128, v128, v130
  s_nop 1
  v_add_f32_dpp v128, v128, v128 row_ror:8 row_mask:0xf bank_mask:0xf
  ds_write_b32 v7, v128
  s_waitcnt lgkmcnt(0)
  s_barrier
  s_cmp_lg_u32 s3, 0
  s_cbranch_scc1 Lend
  s_mov_b64 exec, 0xffff
  ds_read2_b32 v[168:169], v22 offset0:0 offset1:8
  ds_read2_b32 v[170:171], v22 offset0:32 offset1:40
  ds_read2_b32 v[172:173], v22 offset0:64 offset1:72
  ds_read2_b32 v[174:175], v22 offset0:96 offset1:104
  ds_read2_b32 v[176:177], v22 offset0:128 offset1:136
  ds_read2_b32 v[178:179], v22 offset0:160 offset1:168
  ds_read2_b32 v[180:181], v22 offset0:192 offset1:200
  ds_read2_b32 v[182:183], v22 offset0:224 offset1:232
  v_and_b32 v129, s60, v28
  v_lshlrev_b32 v128, 16, v28
  v_and_b32 v131, s60, v29
  v_lshlrev_b32 v130, 16, v29
  s_waitcnt lgkmcnt(4)
  v_pk_add_f32 v[168:169], v[168:169], v[170:171]
  v_pk_add_f32 v[172:173], v[172:173], v[174:175]
  s_waitcnt lgkmcnt(0)
  v_pk_add_f32 v[176:177], v[176:177], v[178:179]
  v_pk_add_f32 v[180:181], v[180:181], v[182:183]
  v_pk_add_f32 v[168:169], v[168:169], v[172:173]
  v_pk_add_f32 v[176:177], v[176:177], v[180:181]
  v_pk_add_f32 v[168:169], v[168:169], v[176:177]
  v_cvt_pk_bf16_f32 v170, v168, v169
  v_and_b32 v169, s60, v170
  v_lshlrev_b32 v168, 16, v170
  v_mul_f32 v168, v168, v27
  v_mul_f32 v169, v169, v27
  v_cvt_pk_bf16_f32 v170, v168, v169
  v_and_b32 v169, s60, v170
  v_lshlrev_b32 v168, 16, v170
  v_pk_add_f32 v[168:169], v[168:169], v[128:129]
  v_cvt_pk_bf16_f32 v170, v168, v169
  v_and_b32 v169, s60, v170
  v_lshlrev_b32 v168, 16, v170
  v_pk_add_f32 v[168:169], v[168:169], v[130:131]
  v_cvt_pk_bf16_f32 v170, v168, v169
  buffer_store_dword v170, v26, s[40:43], s66 offen sc1
  s_branch Lend
Lkst:
  s_lshl_b32 s62, s62, 12
  s_sub_u32 s63, s3, 5
  s_lshl_b32 s63, s63, 10
  s_add_u32 s64, s62, s63
  v_lshlrev_b32 v2, 4, v1
  v_add_u32 v10, s63, v2
  s_lshr_b32 s65, s62, 11
  v_lshlrev_b32 v3, 2, v1
  buffer_load_ushort v11, v3, s[44:47], s65 offen
  buffer_load_dwordx4 v[64:67], v2, s[28:31], s64 offen offset:0
  buffer_load_dwordx2 v[68:69], v2, s[28:31], s64 offen offset:16
  buffer_load_dwordx4 v[70:73], v2, s[28:31], s64 offen offset:2048
  buffer_load_dwordx2 v[74:75], v2, s[28:31], s64 offen offset:2064
  s_add_u32 s64, s64, 8192
  buffer_load_dwordx4 v[76:79], v2, s[28:31], s64 offen offset:0
  buffer_load_dwordx2 v[80:81], v2, s[28:31], s64 offen offset:16
  buffer_load_dwordx4 v[82:85], v2, s[28:31], s64 offen offset:2048
  buffer_load_dwordx2 v[86:87], v2, s[28:31], s64 offen offset:2064
  s_add_u32 s64, s64, 8192
  buffer_load_dwordx4 v[88:91], v2, s[28:31], s64 offen offset:0
  buffer_load_dwordx2 v[92:93], v2, s[28:31], s64 offen offset:16
  buffer_load_dwordx4 v[94:97], v2, s[28:31], s64 offen offset:2048
  buffer_load_dwordx2 v[98:99], v2, s[28:31], s64 offen offset:2064
  s_add_u32 s64, s64, 8192
  buffer_load_dwordx4 v[100:103], v2, s[28:31], s64 offen offset:0
  buffer_load_dwordx2 v[104:105], v2, s[28:31], s64 offen offset:16
  buffer_load_dwordx4 v[106:109], v2, s[28:31], s64 offen offset:2048
  buffer_load_dwordx2 v[110:111], v2, s[28:31], s64 offen offset:2064
  s_waitcnt vmcnt(14)
  v_lshlrev_b32 v11, 16, v11
  s_cmp_lg_u32 s3, 5
  s_cbranch_scc1 Lnf0
  v_readlane_b32 s65, v11, 0
  v_lshlrev_b32 v12, 16, v64
  s_nop 0
  v_add_f32 v12, s65, v12
  v_cvt_pk_bf16_f32 v12, v12, v12
  v_bfi_b32 v12, s60, v64, v12
  s_mov_b64 exec, 1
  v_mov_b32 v64, v12
  s_mov_b64 exec, -1
Lnf0:
  ds_write_b128 v10, v[64:67] offset:32
  v_alignbit_b32 v112, v65, v64, 16
  v_alignbit_b32 v113, v66, v65, 16
  v_alignbit_b32 v114, v67, v66, 16
  v_alignbit_b32 v115, v68, v67, 16
  ds_write_b128 v10, v[112:115] offset:4192
  v_mov_b32 v116, v65
  v_mov_b32 v117, v66
  v_mov_b32 v118, v67
  v_mov_b32 v119, v68
  ds_write_b128 v10, v[116:119] offset:8352
  v_alignbit_b32 v120, v66, v65, 16
  v_alignbit_b32 v121, v67, v66, 16
  v_alignbit_b32 v122, v68, v67, 16
  v_alignbit_b32 v123, v69, v68, 16
  ds_write_b128 v10, v[120:123] offset:12512
  s_waitcnt vmcnt(12)
  ds_write_b128 v10, v[70:73] offset:2080
  v_alignbit_b32 v124, v71, v70, 16
  v_alignbit_b32 v125, v72, v71, 16
  v_alignbit_b32 v126, v73, v72, 16
  v_alignbit_b32 v127, v74, v73, 16
  ds_write_b128 v10, v[124:127] offset:6240
  v_mov_b32 v128, v71
  v_mov_b32 v129, v72
  v_mov_b32 v130, v73
  v_mov_b32 v131, v74
  ds_write_b128 v10, v[128:131] offset:10400
  v_alignbit_b32 v132, v72, v71, 16
  v_alignbit_b32 v133, v73, v72, 16
  v_alignbit_b32 v134, v74, v73, 16
  v_alignbit_b32 v135, v75, v74, 16
  ds_write_b128 v10, v[132:135] offset:14560
  s_waitcnt vmcnt(10)
  s_cmp_lg_u32 s3, 5
  s_cbranch_scc1 Lnf2
  v_readlane_b32 s65, v11, 1
  v_lshlrev_b32 v12, 16, v76
  s_nop 0
  v_add_f32 v12, s65, v12
  v_cvt_pk_bf16_f32 v12, v12, v12
  v_bfi_b32 v12, s60, v76, v12
  s_mov_b64 exec, 1
  v_mov_b32 v76, v12
  s_mov_b64 exec, -1
Lnf2:
  ds_write_b128 v10, v[76:79] offset:16672
  v_alignbit_b32 v112, v77, v76, 16
  v_alignbit_b32 v113, v78, v77, 16
  v_alignbit_b32 v114, v79, v78, 16
  v_alignbit_b32 v115, v80, v79, 16
  ds_write_b128 v10, v[112:115] offset:20832
  v_mov_b32 v116, v77
  v_mov_b32 v117, v78
  v_mov_b32 v118, v79
  v_mov_b32 v119, v80
  ds_write_b128 v10, v[116:119] offset:24992
  v_alignbit_b32 v120, v78, v77, 16
  v_alignbit_b32 v121, v79, v78, 16
  v_alignbit_b32 v122, v80, v79, 16
  v_alignbit_b32 v123, v81, v80, 16
  ds_write_b128 v10, v[120:123] offset:29152
  s_waitcnt vmcnt(8)
  ds_write_b128 v10, v[82:85] offset:18720
  v_alignbit_b32 v124, v83, v82, 16
  v_alignbit_b32 v125, v84, v83, 16
  v_alignbit_b32 v126, v85, v84, 16
  v_alignbit_b32 v127, v86, v85, 16
  ds_write_b128 v10, v[124:127] offset:22880
  v_mov_b32 v128, v83
  v_mov_b32 v129, v84
  v_mov_b32 v130, v85
  v_mov_b32 v131, v86
  ds_write_b128 v10, v[128:131] offset:27040
  v_alignbit_b32 v132, v84, v83, 16
  v_alignbit_b32 v133, v85, v84, 16
  v_alignbit_b32 v134, v86, v85, 16
  v_alignbit_b32 v135, v87, v86, 16
  ds_write_b128 v10, v[132:135] offset:31200
  s_waitcnt vmcnt(6)
  s_cmp_lg_u32 s3, 5
  s_cbranch_scc1 Lnf4
  v_readlane_b32 s65, v11, 2
  v_lshlrev_b32 v12, 16, v88
  s_nop 0
  v_add_f32 v12, s65, v12
  v_cvt_pk_bf16_f32 v12, v12, v12
  v_bfi_b32 v12, s60, v88, v12
  s_mov_b64 exec, 1
  v_mov_b32 v88, v12
  s_mov_b64 exec, -1
Lnf4:
  ds_write_b128 v10, v[88:91] offset:33312
  v_alignbit_b32 v112, v89, v88, 16
  v_alignbit_b32 v113, v90, v89, 16
  v_alignbit_b32 v114, v91, v90, 16
  v_alignbit_b32 v115, v92, v91, 16
  ds_write_b128 v10, v[112:115] offset:37472
  v_mov_b32 v116, v89
  v_mov_b32 v117, v90
  v_mov_b32 v118, v91
  v_mov_b32 v119, v92
  ds_write_b128 v10, v[116:119] offset:41632
  v_alignbit_b32 v120, v90, v89, 16
  v_alignbit_b32 v121, v91, v90, 16
  v_alignbit_b32 v122, v92, v91, 16
  v_alignbit_b32 v123, v93, v92, 16
  ds_write_b128 v10, v[120:123] offset:45792
  s_waitcnt vmcnt(4)
  ds_write_b128 v10, v[94:97] offset:35360
  v_alignbit_b32 v124, v95, v94, 16
  v_alignbit_b32 v125, v96, v95, 16
  v_alignbit_b32 v126, v97, v96, 16
  v_alignbit_b32 v127, v98, v97, 16
  ds_write_b128 v10, v[124:127] offset:39520
  v_mov_b32 v128, v95
  v_mov_b32 v129, v96
  v_mov_b32 v130, v97
  v_mov_b32 v131, v98
  ds_write_b128 v10, v[128:131] offset:43680
  v_alignbit_b32 v132, v96, v95, 16
  v_alignbit_b32 v133, v97, v96, 16
  v_alignbit_b32 v134, v98, v97, 16
  v_alignbit_b32 v135, v99, v98, 16
  ds_write_b128 v10, v[132:135] offset:47840
  s_waitcnt vmcnt(2)
  s_cmp_lg_u32 s3, 5
  s_cbranch_scc1 Lnf6
  v_readlane_b32 s65, v11, 3
  v_lshlrev_b32 v12, 16, v100
  s_nop 0
  v_add_f32 v12, s65, v12
  v_cvt_pk_bf16_f32 v12, v12, v12
  v_bfi_b32 v12, s60, v100, v12
  s_mov_b64 exec, 1
  v_mov_b32 v100, v12
  s_mov_b64 exec, -1
Lnf6:
  ds_write_b128 v10, v[100:103] offset:49952
  v_alignbit_b32 v112, v101, v100, 16
  v_alignbit_b32 v113, v102, v101, 16
  v_alignbit_b32 v114, v103, v102, 16
  v_alignbit_b32 v115, v104, v103, 16
  ds_write_b128 v10, v[112:115] offset:54112
  v_mov_b32 v116, v101
  v_mov_b32 v117, v102
  v_mov_b32 v118, v103
  v_mov_b32 v119, v104
  ds_write_b128 v10, v[116:119] offset:58272
  v_alignbit_b32 v120, v102, v101, 16
  v_alignbit_b32 v121, v103, v102, 16
  v_alignbit_b32 v122, v104, v103, 16
  v_alignbit_b32 v123, v105, v104, 16
  ds_write_b128 v10, v[120:123] offset:62432
  s_waitcnt vmcnt(0)
  ds_write_b128 v10, v[106:109] offset:52000
  v_alignbit_b32 v124, v107, v106, 16
  v_alignbit_b32 v125, v108, v107, 16
  v_alignbit_b32 v126, v109, v108, 16
  v_alignbit_b32 v127, v110, v109, 16
  ds_write_b128 v10, v[124:127] offset:56160
  v_mov_b32 v128, v107
  v_mov_b32 v129, v108
  v_mov_b32 v130, v109
  v_mov_b32 v131, v110
  ds_write_b128 v10, v[128:131] offset:60320
  v_alignbit_b32 v132, v108, v107, 16
  v_alignbit_b32 v133, v109, v108, 16
  v_alignbit_b32 v134, v110, v109, 16
  v_alignbit_b32 v135, v111, v110, 16
  ds_write_b128 v10, v[132:135] offset:64480
  s_lshl_b32 s63, s3, 2
  s_add_u32 s63, s63, 102516
  v_mov_b32 v2, s63
  v_mov_b32 v3, 1
  ds_write_b32 v2, v3
  s_waitcnt lgkmcnt(0)
  s_barrier
  s_branch Lhelp0
Lffn_aux:
  s_mul_i32 s66, s3, 3
  s_sub_u32 s66, s66, 15
  s_lshl_b32 s67, s6, 3
  v_lshlrev_b32 v2, 4, v1
  v_lshlrev_b32 v3, 2, v1
  s_add_u32 s68, s66, 0
  s_min_u32 s68, s68, 7
  s_mul_i32 s69, s68, 2560
  s_add_u32 s68, s68, s67
  s_mul_i32 s68, s68, 1280
  s_add_u32 s69, s69, 102592
  buffer_load_dwordx4 v[128:131], v2, s[32:35], s68 offen
  buffer_load_dword v132, v3, s[32:35], s68 offen offset:1024
  v_add_u32 v16, s69, v2
  v_add_u32 v17, s69, v3
  s_add_u32 s68, s66, 1
  s_min_u32 s68, s68, 7
  s_mul_i32 s69, s68, 2560
  s_add_u32 s68, s68, s67
  s_mul_i32 s68, s68, 1280
  s_add_u32 s69, s69, 102592
  buffer_load_dwordx4 v[134:137], v2, s[32:35], s68 offen
  buffer_load_dword v138, v3, s[32:35], s68 offen offset:1024
  v_add_u32 v18, s69, v2
  v_add_u32 v19, s69, v3
  s_add_u32 s68, s66, 2
  s_min_u32 s68, s68, 7
  s_mul_i32 s69, s68, 2560
  s_add_u32 s68, s68, s67
  s_mul_i32 s68, s68, 1280
  s_add_u32 s69, s69, 102592
  buffer_load_dwordx4 v[140:143], v2, s[32:35], s68 offen
  buffer_load_dword v144, v3, s[32:35], s68 offen offset:1024
  v_add_u32 v20, s69, v2
  v_add_u32 v21, s69, v3
  buffer_load_dwordx4 v[148:151], v2, s[36:39], 0 offen
  buffer_load_dword v152, v3, s[36:39], 0 offen offset:1024
  s_barrier
Lln1:
  s_mov_b32 s81, 0x3f803f80
  s_movk_i32 s77, 0x3f80
  s_mov_b32 s80, 0x3f800000
  v_mov_b32 v164, 0x3acccccd
  v_add_u32 v6, 123072, v2
  v_add_u32 v7, 123072, v3
  v_mov_b32 v4, 124352
  s_waitcnt vmcnt(6)
  ds_write_b128 v16, v[128:131]
  ds_write_b32 v17, v132 offset:1024
  v_dot2_f32_bf16 v156, v128, s81, 0
  v_dot2_f32_bf16 v157, v128, v128, 0
  v_dot2_f32_bf16 v156, v129, s81, v156
  v_dot2_f32_bf16 v157, v129, v129, v157
  v_dot2_f32_bf16 v156, v130, s81, v156
  v_dot2_f32_bf16 v157, v130, v130, v157
  v_dot2_f32_bf16 v156, v131, s81, v156
  v_dot2_f32_bf16 v157, v131, v131, v157
  v_dot2_f32_bf16 v156, v132, s81, v156
  v_dot2_f32_bf16 v157, v132, v132, v157
  s_waitcnt vmcnt(4)
  ds_write_b128 v18, v[134:137]
  ds_write_b32 v19, v138 offset:1024
  v_dot2_f32_bf16 v158, v134, s81, 0
  v_dot2_f32_bf16 v159, v134, v134, 0
  v_dot2_f32_bf16 v158, v135, s81, v158
  v_dot2_f32_bf16 v159, v135, v135, v159
  v_dot2_f32_bf16 v158, v136, s81, v158
  v_dot2_f32_bf16 v159, v136, v136, v159
  v_dot2_f32_bf16 v158, v137, s81, v158
  v_dot2_f32_bf16 v159, v137, v137, v159
  v_dot2_f32_bf16 v158, v138, s81, v158
  v_dot2_f32_bf16 v159, v138, v138, v159
  s_waitcnt vmcnt(2)
  ds_write_b128 v20, v[140:143]
  ds_write_b32 v21, v144 offset:1024
  v_dot2_f32_bf16 v160, v140, s81, 0
  v_dot2_f32_bf16 v161, v140, v140, 0
  v_dot2_f32_bf16 v160, v141, s81, v160
  v_dot2_f32_bf16 v161, v141, v141, v161
  v_dot2_f32_bf16 v160, v142, s81, v160
  v_dot2_f32_bf16 v161, v142, v142, v161
  v_dot2_f32_bf16 v160, v143, s81, v160
  v_dot2_f32_bf16 v161, v143, v143, v161
  v_dot2_f32_bf16 v160, v144, s81, v160
  v_dot2_f32_bf16 v161, v144, v144, v161
  s_waitcnt vmcnt(0)
  ds_write_b128 v6, v[148:151]
  ds_write_b32 v7, v152 offset:1024
  v_dot2_f32_bf16 v162, v148, s81, 0
  v_dot2_f32_bf16 v162, v149, s81, v162
  v_dot2_f32_bf16 v162, v150, s81, v162
  v_dot2_f32_bf16 v162, v151, s81, v162
  v_dot2_f32_bf16 v162, v152, s81, v162
  v_add_f32_dpp v156, v156, v156 row_shr:1 row_mask:0xf bank_mask:0xf bound_ctrl:1
  v_add_f32_dpp v157, v157, v157 row_shr:1 row_mask:0xf bank_mask:0xf bound_ctrl:1
  v_add_f32_dpp v158, v158, v158 row_shr:1 row_mask:0xf bank_mask:0xf bound_ctrl:1
  v_add_f32_dpp v159, v159, v159 row_shr:1 row_mask:0xf bank_mask:0xf bound_ctrl:1
  v_add_f32_dpp v160, v160, v160 row_shr:1 row_mask:0xf bank_mask:0xf bound_ctrl:1
  v_add_f32_dpp v161, v161, v161 row_shr:1 row_mask:0xf bank_mask:0xf bound_ctrl:1
  v_add_f32_dpp v162, v162, v162 row_shr:1 row_mask:0xf bank_mask:0xf bound_ctrl:1
  v_add_f32_dpp v156, v156, v156 row_shr:2 row_mask:0xf bank_mask:0xf bound_ctrl:1
  v_add_f32_dpp v157, v157, v157 row_shr:2 row_mask:0xf bank_mask:0xf bound_ctrl:1
  v_add_f32_dpp v158, v158, v158 row_shr:2 row_mask:0xf bank_mask:0xf bound_ctrl:1
  v_add_f32_dpp v159, v159, v159 row_shr:2 row_mask:0xf bank_mask:0xf bound_ctrl:1
  v_add_f32_dpp v160, v160, v160 row_shr:2 row_mask:0xf bank_mask:0xf bound_ctrl:1
  v_add_f32_dpp v161, v161, v161 row_shr:2 row_mask:0xf bank_mask:0xf bound_ctrl:1
  v_add_f32_dpp v162, v162, v162 row_shr:2 row_mask:0xf bank_mask:0xf bound_ctrl:1
  v_add_f32_dpp v156, v156, v156 row_shr:4 row_mask:0xf bank_mask:0xf bound_ctrl:1
  v_add_f32_dpp v157, v157, v157 row_shr:4 row_mask:0xf bank_mask:0xf bound_ctrl:1
  v_add_f32_dpp v158, v158, v158 row_shr:4 row_mask:0xf bank_mask:0xf bound_ctrl:1
  v_add_f32_dpp v159, v159, v159 row_shr:4 row_mask:0xf bank_mask:0xf bound_ctrl:1
  v_add_f32_dpp v160, v160, v160 row_shr:4 row_mask:0xf bank_mask:0xf bound_ctrl:1
  v_add_f32_dpp v161, v161, v161 row_shr:4 row_mask:0xf bank_mask:0xf bound_ctrl:1
  v_add_f32_dpp v162, v162, v162 row_shr:4 row_mask:0xf bank_mask:0xf bound_ctrl:1
  v_add_f32_dpp v156, v156, v156 row_shr:8 row_mask:0xf bank_mask:0xf bound_ctrl:1
  v_add_f32_dpp v157, v157, v157 row_shr:8 row_mask:0xf bank_mask:0xf bound_ctrl:1
  v_add_f32_dpp v158, v158, v158 row_shr:8 row_mask:0xf bank_mask:0xf bound_ctrl:1
  v_add_f32_dpp v159, v159, v159 row_shr:8 row_mask:0xf bank_mask:0xf bound_ctrl:1
  v_add_f32_dpp v160, v160, v160 row_shr:8 row_mask:0xf bank_mask:0xf bound_ctrl:1
  v_add_f32_dpp v161, v161, v161 row_shr:8 row_mask:0xf bank_mask:0xf bound_ctrl:1
  v_add_f32_dpp v162, v162, v162 row_shr:8 row_mask:0xf bank_mask:0xf bound_ctrl:1
  v_add_f32_dpp v156, v156, v156 row_bcast:15 row_mask:0xa bank_mask:0xf
  v_add_f32_dpp v157, v157, v157 row_bcast:15 row_mask:0xa bank_mask:0xf
  v_add_f32_dpp v158, v158, v158 row_bcast:15 row_mask:0xa bank_mask:0xf
  v_add_f32_dpp v159, v159, v159 row_bcast:15 row_mask:0xa bank_mask:0xf
  v_add_f32_dpp v160, v160, v160 row_bcast:15 row_mask:0xa bank_mask:0xf
  v_add_f32_dpp v161, v161, v161 row_bcast:15 row_mask:0xa bank_mask:0xf
  v_add_f32_dpp v162, v162, v162 row_bcast:15 row_mask:0xa bank_mask:0xf
  v_add_f32_dpp v156, v156, v156 row_bcast:31 row_mask:0xc bank_mask:0xf
  v_add_f32_dpp v157, v157, v157 row_bcast:31 row_mask:0xc bank_mask:0xf
  v_add_f32_dpp v158, v158, v158 row_bcast:31 row_mask:0xc bank_mask:0xf
  v_add_f32_dpp v159, v159, v159 row_bcast:31 row_mask:0xc bank_mask:0xf
  v_add_f32_dpp v160, v160, v160 row_bcast:31 row_mask:0xc bank_mask:0xf
  v_add_f32_dpp v161, v161, v161 row_bcast:31 row_mask:0xc bank_mask:0xf
  v_add_f32_dpp v162, v162, v162 row_bcast:31 row_mask:0xc bank_mask:0xf
  s_mov_b32 exec_lo, 0
  s_brev_b32 exec_hi, 1
  ds_write_b32 v4, v162
  s_mov_b64 exec, -1
  v_mul_f32 v156, v156, v164
  v_mul_f32 v158, v158, v164
  v_mul_f32 v160, v160, v164
  v_mul_f32 v157, v157, v164
  v_mul_f32 v159, v159, v164
  v_mul_f32 v161, v161, v164
  v_fma_f32 v157, -v156, v156, v157
  v_fma_f32 v159, -v158, v158, v159
  v_fma_f32 v161, -v160, v160, v161
  v_max_f32 v157, 0, v157
  v_max_f32 v159, 0, v159
  v_max_f32 v161, 0, v161
  v_cvt_pk_bf16_f32 v157, v157, v157
  v_cvt_pk_bf16_f32 v159, v159, v159
  v_cvt_pk_bf16_f32 v161, v161, v161
  v_and_b32 v157, s60, v157
  v_and_b32 v159, s60, v159
  v_and_b32 v161, s60, v161
  v_add_f32 v157, 0x3727c5ac, v157
  v_add_f32 v159, 0x3727c5ac, v159
  v_add_f32 v161, 0x3727c5ac, v161
  v_cvt_pk_bf16_f32 v157, v157, v157
  v_cvt_pk_bf16_f32 v159, v159, v159
  v_cvt_pk_bf16_f32 v161, v161, v161
  v_and_b32 v157, s60, v157
  v_and_b32 v159, s60, v159
  v_and_b32 v161, s60, v161
  v_sqrt_f32 v157, v157
  v_sqrt_f32 v159, v159
  v_sqrt_f32 v161, v161
  v_cvt_pk_bf16_f32 v156, -v156, -v156
  v_cvt_pk_bf16_f32 v158, -v158, -v158
  v_cvt_pk_bf16_f32 v160, -v160, -v160
  v_cvt_pk_bf16_f32 v157, v157, v157
  v_cvt_pk_bf16_f32 v159, v159, v159
  v_cvt_pk_bf16_f32 v161, v161, v161
  v_and_b32 v156, s60, v156
  v_and_b32 v158, s60, v158
  v_and_b32 v160, s60, v160
  v_and_b32 v157, s60, v157
  v_and_b32 v159, s60, v159
  v_and_b32 v161, s60, v161
  v_rcp_f32 v157, v157
  v_rcp_f32 v159, v159
  v_rcp_f32 v161, v161
  v_readlane_b32 s63, v156, 63
  v_readlane_b32 s64, v158, 63
  v_readlane_b32 s65, v160, 63
  v_readlane_b32 s66, v157, 63
  v_readlane_b32 s67, v159, 63
  v_readlane_b32 s68, v161, 63
  v_mov_b32 v165, s63
  v_mov_b32 v166, s66
  v_mov_b32 v167, s66
  v_dot2_f32_bf16 v170, v128, s77, v165
  v_dot2_f32_bf16 v171, v128, s80, v165
  v_dot2_f32_bf16 v172, v129, s77, v165
  v_dot2_f32_bf16 v173, v129, s80, v165
  v_dot2_f32_bf16 v174, v130, s77, v165
  v_dot2_f32_bf16 v175, v130, s80, v165
  v_dot2_f32_bf16 v176, v131, s77, v165
  v_dot2_f32_bf16 v177, v131, s80, v165
  v_dot2_f32_bf16 v178, v132, s77, v165
  v_dot2_f32_bf16 v179, v132, s80, v165
  v_cvt_pk_bf16_f32 v180, v170, v171
  v_cvt_pk_bf16_f32 v181, v172, v173
  v_cvt_pk_bf16_f32 v182, v174, v175
  v_cvt_pk_bf16_f32 v183, v176, v177
  v_cvt_pk_bf16_f32 v184, v178, v179
  v_and_b32 v171, s60, v180
  v_lshlrev_b32 v170, 16, v180
  v_and_b32 v173, s60, v181
  v_lshlrev_b32 v172, 16, v181
  v_and_b32 v175, s60, v182
  v_lshlrev_b32 v174, 16, v182
  v_and_b32 v177, s60, v183
  v_lshlrev_b32 v176, 16, v183
  v_and_b32 v179, s60, v184
  v_lshlrev_b32 v178, 16, v184
  v_pk_mul_f32 v[170:171], v[170:171], v[166:167]
  v_pk_mul_f32 v[172:173], v[172:173], v[166:167]
  v_pk_mul_f32 v[174:175], v[174:175], v[166:167]
  v_pk_mul_f32 v[176:177], v[176:177], v[166:167]
  v_pk_mul_f32 v[178:179], v[178:179], v[166:167]
  v_cvt_pk_bf16_f32 v180, v170, v171
  v_cvt_pk_bf16_f32 v181, v172, v173
  v_cvt_pk_bf16_f32 v182, v174, v175
  v_cvt_pk_bf16_f32 v183, v176, v177
  v_cvt_pk_bf16_f32 v184, v178, v179
  ds_write_b128 v16, v[180:183] offset:1280
  ds_write_b32 v17, v184 offset:2304
  v_mov_b32 v165, s64
  v_mov_b32 v166, s67
  v_mov_b32 v167, s67
  v_dot2_f32_bf16 v170, v134, s77, v165
  v_dot2_f32_bf16 v171, v134, s80, v165
  v_dot2_f32_bf16 v172, v135, s77, v165
  v_dot2_f32_bf16 v173, v135, s80, v165
  v_dot2_f32_bf16 v174, v136, s77, v165
  v_dot2_f32_bf16 v175, v136, s80, v165
  v_dot2_f32_bf16 v176, v137, s77, v165
  v_dot2_f32_bf16 v177, v137, s80, v165
  v_dot2_f32_bf16 v178, v138, s77, v165
  v_dot2_f32_bf16 v179, v138, s80, v165
  v_cvt_pk_bf16_f32 v180, v170, v171
  v_cvt_pk_bf16_f32 v181, v172, v173
  v_cvt_pk_bf16_f32 v182, v174, v175
  v_cvt_pk_bf16_f32 v183, v176, v177
  v_cvt_pk_bf16_f32 v184, v178, v179
  v_and_b32 v171, s60, v180
  v_lshlrev_b32 v170, 16, v180
  v_and_b32 v173, s60, v181
  v_lshlrev_b32 v172, 16, v181
  v_and_b32 v175, s60, v182
  v_lshlrev_b32 v174, 16, v182
  v_and_b32 v177, s60, v183
  v_lshlrev_b32 v176, 16, v183
  v_and_b32 v179, s60, v184
  v_lshlrev_b32 v178, 16, v184
  v_pk_mul_f32 v[170:171], v[170:171], v[166:167]
  v_pk_mul_f32 v[172:173], v[172:173], v[166:167]
  v_pk_mul_f32 v[174:175], v[174:175], v[166:167]
  v_pk_mul_f32 v[176:177], v[176:177], v[166:167]
  v_pk_mul_f32 v[178:179], v[178:179], v[166:167]
  v_cvt_pk_bf16_f32 v180, v170, v171
  v_cvt_pk_bf16_f32 v181, v172, v173
  v_cvt_pk_bf16_f32 v182, v174, v175
  v_cvt_pk_bf16_f32 v183, v176, v177
  v_cvt_pk_bf16_f32 v184, v178, v179
  ds_write_b128 v18, v[180:183] offset:1280
  ds_write_b32 v19, v184 offset:2304
  v_mov_b32 v165, s65
  v_mov_b32 v166, s68
  v_mov_b32 v167, s68
  v_dot2_f32_bf16 v170, v140, s77, v165
  v_dot2_f32_bf16 v171, v140, s80, v165
  v_dot2_f32_bf16 v172, v141, s77, v165
  v_dot2_f32_bf16 v173, v141, s80, v165
  v_dot2_f32_bf16 v174, v142, s77, v165
  v_dot2_f32_bf16 v175, v142, s80, v165
  v_dot2_f32_bf16 v176, v143, s77, v165
  v_dot2_f32_bf16 v177, v143, s80, v165
  v_dot2_f32_bf16 v178, v144, s77, v165
  v_dot2_f32_bf16 v179, v144, s80, v165
  v_cvt_pk_bf16_f32 v180, v170, v171
  v_cvt_pk_bf16_f32 v181, v172, v173
  v_cvt_pk_bf16_f32 v182, v174, v175
  v_cvt_pk_bf16_f32 v183, v176, v177
  v_cvt_pk_bf16_f32 v184, v178, v179
  v_and_b32 v171, s60, v180
  v_lshlrev_b32 v170, 16, v180
  v_and_b32 v173, s60, v181
  v_lshlrev_b32 v172, 16, v181
  v_and_b32 v175, s60, v182
  v_lshlrev_b32 v174, 16, v182
  v_and_b32 v177, s60, v183
  v_lshlrev_b32 v176, 16, v183
  v_and_b32 v179, s60, v184
  v_lshlrev_b32 v178, 16, v184
  v_pk_mul_f32 v[170:171], v[170:171], v[166:167]
  v_pk_mul_f32 v[172:173], v[172:173], v[166:167]
  v_pk_mul_f32 v[174:175], v[174:175], v[166:167]
  v_pk_mul_f32 v[176:177], v[176:177], v[166:167]
  v_pk_mul_f32 v[178:179], v[178:179], v[166:167]
  v_cvt_pk_bf16_f32 v180, v170, v171
  v_cvt_pk_bf16_f32 v181, v172, v173
  v_cvt_pk_bf16_f32 v182, v174, v175
  v_cvt_pk_bf16_f32 v183, v176, v177
  v_cvt_pk_bf16_f32 v184, v178, v179
  ds_write_b128 v20, v[180:183] offset:1280
  ds_write_b32 v21, v184 offset:2304
  s_cmp_lg_u32 s3, 7
  s_cbranch_scc1 Lffn_pre2
  v_lshlrev_b32 v21, 7, v1
  s_mov_b32 s63, 4456448
  s_mov_b32 s64, 4464640
  s_mov_b32 s65, 4472832
  s_mov_b32 s68, 4481024
  s_mov_b32 s61, 0
Lc3:
  buffer_load_dwordx4 v[16:19], v21, s[20:23], s63 offen sc1
  s_waitcnt vmcnt(0)
  v_xor_b32 v16, s89, v16
  v_xor_b32 v17, s89, v17
  v_xor_b32 v18, s89, v18
  v_xor_b32 v19, s89, v19
  v_or3_b32 v16, v16, v17, v18
  v_or_b32 v16, v16, v19
  v_cmp_ne_u32 vcc, 0, v16
  s_cbranch_vccz Lc3ok
  s_mov_b64 exec, vcc
  s_add_u32 s61, s61, 1
  s_cmp_lt_u32 s61, 40000
  s_cbranch_scc1 Lc3
Lc3ok:
  s_mov_b64 exec, -1
  s_branch Lffn_pre2
Lcnt:
  s_sleep 24
  v_lshlrev_b32 v21, 7, v1
  s_mov_b32 s63, 4456448
  s_mov_b32 s64, 4464640
  s_mov_b32 s65, 4472832
  s_mov_b32 s68, 4481024
  s_mov_b32 s61, 0
Lc1:
  buffer_load_dwordx4 v[16:19], v21, s[20:23], s63 offen sc1
  s_waitcnt vmcnt(0)
  v_xor_b32 v16, s89, v16
  v_xor_b32 v17, s89, v17
  v_xor_b32 v18, s89, v18
  v_xor_b32 v19, s89, v19
  v_or3_b32 v16, v16, v17, v18
  v_or_b32 v16, v16, v19
  v_cmp_ne_u32 vcc, 0, v16
  s_cbranch_vccz Lc1ok
  s_mov_b64 exec, vcc
  s_add_u32 s61, s61, 1
  s_cmp_lt_u32 s61, 40000
  s_cbranch_scc1 Lc1
Lc1ok:
  s_mov_b64 exec, -1
  v_mov_b32 v2, 102528
  v_mov_b32 v20, 1
  ds_write_b32 v2, v20
Lb1h:
  s_waitcnt lgkmcnt(0)
  s_barrier
  s_branch Lhelp0
Lffn_pre:
  v_lshlrev_b32 v2, 4, v1
  v_lshrrev_b32 v4, 1, v1
  v_and_b32 v5, 1, v1
  v_mul_u32_u24 v6, 3072, v4
  v_lshl_add_u32 v6, v5, 4, v6
  s_and_b32 s67, s7, 3
  s_cmp_ge_u32 s3, 2
  s_cbranch_scc1 Lw_d
  s_mul_i32 s63, s67, 491520
  s_lshl_b32 s64, s7, 5
  s_add_u32 s63, s63, s64
  s_mul_i32 s65, s67, 5120
  s_mul_i32 s64, s3, 20480
  s_add_u32 s65, s65, s64
  s_cmp_lg_u32 s3, 0
  s_cselect_b32 s92, s52, s48
  s_cselect_b32 s93, s53, s49
  s_mov_b32 s94, 1966080
  s_mov_b32 s95, 0x20000
  s_barrier
  s_mov_b32 m0, s65
  s_add_u32 s65, s65, 1024
  buffer_load_dwordx4 v6, s[92:95], s63 offen  lds
  s_add_u32 s63, s63, 98304
  s_mov_b32 m0, s65
  s_add_u32 s65, s65, 1024
  buffer_load_dwordx4 v6, s[92:95], s63 offen  lds
  s_add_u32 s63, s63, 98304
  s_mov_b32 m0, s65
  s_add_u32 s65, s65, 1024
  buffer_load_dwordx4 v6, s[92:95], s63 offen  lds
  s_add_u32 s63, s63, 98304
  s_mov_b32 m0, s65
  s_add_u32 s65, s65, 1024
  buffer_load_dwordx4 v6, s[92:95], s63 offen  lds
  s_add_u32 s63, s63, 98304
  s_mov_b32 m0, s65
  s_add_u32 s65, s65, 1024
  buffer_load_dwordx4 v6, s[92:95], s63 offen  lds
  s_add_u32 s63, s63, 98304
  s_branch Lw_r1
Lw_d:
  s_sub_u32 s66, s3, 2
  s_mul_i32 s66, s66, 6656
  s_mul_i32 s68, s7, 20480
  s_add_u32 s68, s68, s66
  s_add_u32 s66, s66, 40960
  s_mov_b32 m0, s66
  s_add_u32 s66, s66, 4096
  s_barrier
  buffer_load_dwordx4 v2, s[56:59], s68 offen offset:0  lds
  buffer_load_dwordx4 v2, s[56:59], s68 offen offset:1024  lds
  buffer_load_dwordx4 v2, s[56:59], s68 offen offset:2048  lds
  buffer_load_dwordx4 v2, s[56:59], s68 offen offset:3072  lds
  s_mov_b32 m0, s66
  s_add_u32 s68, s68, 4096
  buffer_load_dwordx4 v2, s[56:59], s68 offen offset:0  lds
  buffer_load_dwordx4 v2, s[56:59], s68 offen offset:1024  lds
  buffer_load_dwordx4 v2, s[56:59], s68 offen offset:2048  lds
  s_branch Lw_r1
Lffn_pre2:
  v_lshlrev_b32 v2, 4, v1
  v_lshrrev_b32 v4, 1, v1
  v_and_b32 v5, 1, v1
  v_mul_u32_u24 v6, 3072, v4
  v_lshl_add_u32 v6, v5, 4, v6
  s_and_b32 s67, s7, 3
Lw_r1:
  s_and_b32 s66, s3, 3
  s_lshr_b32 s68, s3, 2
  s_mul_i32 s63, s66, 491520
  s_lshl_b32 s64, s7, 5
  s_add_u32 s63, s63, s64
  s_mul_i32 s65, s66, 5120
  s_mul_i32 s64, s68, 20480
  s_add_u32 s65, s65, s64
  s_cmp_lg_u32 s68, 0
  s_cselect_b32 s92, s52, s48
  s_cselect_b32 s93, s53, s49
  s_mov_b32 s94, 1966080
  s_mov_b32 s95, 0x20000
  s_waitcnt vmcnt(0) lgkmcnt(0)
  s_barrier
  s_cmp_eq_u32 s66, s67
  s_cbranch_scc1 Lffn_q
  s_mov_b32 m0, s65
  s_add_u32 s65, s65, 1024
  buffer_load_dwordx4 v6, s[92:95], s63 offen  lds
  s_add_u32 s63, s63, 98304
  s_mov_b32 m0, s65
  s_add_u32 s65, s65, 1024
  buffer_load_dwordx4 v6, s[92:95], s63 offen  lds
  s_add_u32 s63, s63, 98304
  s_mov_b32 m0, s65
  s_add_u32 s65, s65, 1024
  buffer_load_dwordx4 v6, s[92:95], s63 offen  lds
  s_add_u32 s63, s63, 98304
  s_mov_b32 m0, s65
  s_add_u32 s65, s65, 1024
  buffer_load_dwordx4 v6, s[92:95], s63 offen  lds
  s_add_u32 s63, s63, 98304
  s_mov_b32 m0, s65
  s_add_u32 s65, s65, 1024
  buffer_load_dwordx4 v6, s[92:95], s63 offen  lds
  s_add_u32 s63, s63, 98304
Lffn_q:
  v_lshrrev_b32 v4, 3, v1
  v_mul_u32_u24 v4, 12288, v4
  v_and_b32 v5, 7, v1
  v_lshl_add_u32 v4, v5, 4, v4
  s_mul_i32 s63, s3, 61440
  s_lshl_b32 s64, s7, 7
  s_add_u32 s63, s63, s64
  s_add_u32 s63, s63, 3932160
  v_mov_b32 v48, -1
  v_mov_b32 v49, -1
  v_mov_b32 v50, -1
  v_mov_b32 v51, -1
  s_mov_b32 exec_hi, 0xff
  buffer_store_dwordx4 v[48:51], v4, s[20:23], s63 offen sc1
  s_mov_b32 exec_hi, -1
  v_lshrrev_b32 v4, 4, v1
  v_and_b32 v5, 15, v1
  v_lshlrev_b32 v6, 8, v4
  v_lshl_add_u32 v6, v5, 3, v6
  s_mul_i32 s63, s3, 5120
  v_add_u32 v6, s63, v6
  v_lshrrev_b32 v7, 2, v5
  v_lshl_add_u32 v7, v4, 2, v7
  v_mul_u32_u24 v7, 1280, v7
  v_and_b32 v5, 3, v5
  v_lshl_add_u32 v7, v5, 3, v7
  s_mul_i32 s63, s3, 160
  s_add_u32 s63, s63, 40960
  v_add_u32 v7, s63, v7
  ds_read_b64_tr_b16 v[84:85], v7 offset:0
  ds_read_b64_tr_b16 v[86:87], v7 offset:32
  ds_read_b64_tr_b16 v[88:89], v7 offset:64
  ds_read_b64_tr_b16 v[90:91], v7 offset:96
  ds_read_b64_tr_b16 v[92:93], v7 offset:128
  v_mov_b32 v95, v6
  s_cmp_lt_u32 s3, 4
  s_cbranch_scc1 Lpre2
  s_branch Lhelp
Lhelp0:
  s_cmp_eq_u32 s3, 7
  s_cbranch_scc1 Lnowpf
  s_mul_i32 s63, s5, 98304
  s_mul_i32 s64, s4, 384
  s_add_u32 s63, s63, s64
  s_sub_u32 s64, s3, 4
  s_lshl_b32 s64, s64, 7
  s_add_u32 s63, s63, s64
  v_and_b32 v2, 31, v1
  v_mul_u32_u24 v2, 3072, v2
  s_mov_b32 exec_hi, 0
  buffer_load_dword v100, v2, s[48:51], s63 offen
  buffer_load_dword v101, v2, s[52:55], s63 offen
  s_mov_b32 exec_hi, -1
Lnowpf:
  s_lshl_b32 s63, s6, 3
  s_add_u32 s63, s63, s3
  s_mul_i32 s63, s63, 1280
  s_sub_u32 s64, s63, 5120
  v_lshlrev_b32 v2, 4, v1
  v_lshlrev_b32 v3, 2, v1
  buffer_load_dwordx4 v[10:13], v2, s[32:35], s64 offen
  buffer_load_dword v14, v3, s[32:35], s64 offen offset:1024
  buffer_load_dwordx4 v[16:19], v2, s[32:35], s63 offen
  buffer_load_dword v20, v3, s[32:35], s63 offen offset:1024
  s_mul_i32 s63, s3, 2560
  s_add_u32 s63, s63, 92352
  v_add_u32 v4, s63, v2
  v_add_u32 v5, s63, v3
  s_cmp_lg_u32 s3, 5
  s_cbranch_scc1 Lhelp1
  buffer_load_dwordx4 v[24:27], v2, s[36:39], 0 offen
  buffer_load_dword v28, v3, s[36:39], 0 offen offset:1024
  v_add_u32 v6, 123072, v2
  v_add_u32 v7, 123072, v3
  s_waitcnt vmcnt(0)
  ds_write_b128 v6, v[24:27]
  ds_write_b32 v7, v28 offset:1024
  v_and_b32 v213, s60, v24
  v_lshlrev_b32 v212, 16, v24
  v_and_b32 v215, s60, v25
  v_lshlrev_b32 v214, 16, v25
  v_and_b32 v217, s60, v26
  v_lshlrev_b32 v216, 16, v26
  v_and_b32 v219, s60, v27
  v_lshlrev_b32 v218, 16, v27
  v_and_b32 v221, s60, v28
  v_lshlrev_b32 v220, 16, v28
  v_add_f32 v212, v212, v213
  v_add_f32 v212, v212, v214
  v_add_f32 v212, v212, v215
  v_add_f32 v212, v212, v216
  v_add_f32 v212, v212, v217
  v_add_f32 v212, v212, v218
  v_add_f32 v212, v212, v219
  v_add_f32 v212, v212, v220
  v_add_f32 v212, v212, v221
  s_nop 1
  v_add_f32_dpp v212, v212, v212 row_shr:1 row_mask:0xf bank_mask:0xf bound_ctrl:1
  s_nop 1
  v_add_f32_dpp v212, v212, v212 row_shr:2 row_mask:0xf bank_mask:0xf bound_ctrl:1
  s_nop 1
  v_add_f32_dpp v212, v212, v212 row_shr:4 row_mask:0xf bank_mask:0xf bound_ctrl:1
  s_nop 1
  v_add_f32_dpp v212, v212, v212 row_shr:8 row_mask:0xf bank_mask:0xf bound_ctrl:1
  s_nop 1
  v_add_f32_dpp v212, v212, v212 row_bcast:15 row_mask:0xa bank_mask:0xf
  s_nop 1
  v_add_f32_dpp v212, v212, v212 row_bcast:31 row_mask:0xc bank_mask:0xf
  v_mov_b32 v6, 124352
  s_mov_b32 exec_lo, 0
  s_brev_b32 exec_hi, 1
  ds_write_b32 v6, v212
  s_mov_b64 exec, -1
Lhelp1:
  s_waitcnt vmcnt(2)
  ds_write_b128 v4, v[10:13] offset:0
  ds_write_b32 v5, v14 offset:1024
  v_and_b32 v193, s60, v10
  v_lshlrev_b32 v192, 16, v10
  v_and_b32 v195, s60, v11
  v_lshlrev_b32 v194, 16, v11
  v_and_b32 v197, s60, v12
  v_lshlrev_b32 v196, 16, v12
  v_and_b32 v199, s60, v13
  v_lshlrev_b32 v198, 16, v13
  v_and_b32 v201, s60, v14
  v_lshlrev_b32 v200, 16, v14
  v_add_f32 v128, v192, v194
  v_add_f32 v129, v193, v195
  v_mul_f32 v130, v192, v192
  v_mul_f32 v131, v193, v193
  v_add_f32 v134, v196, v198
  v_add_f32 v135, v197, v199
  v_fma_f32 v130, v194, v194, v130
  v_fma_f32 v131, v195, v195, v131
  v_add_f32 v128, v128, v200
  v_add_f32 v129, v129, v201
  v_fma_f32 v130, v196, v196, v130
  v_fma_f32 v131, v197, v197, v131
  v_add_f32 v128, v128, v134
  v_add_f32 v129, v129, v135
  v_fma_f32 v130, v198, v198, v130
  v_fma_f32 v131, v199, v199, v131
  v_add_f32 v128, v128, v129
  v_fma_f32 v130, v200, v200, v130
  v_fma_f32 v131, v201, v201, v131
  v_add_f32 v130, v130, v131
  v_add_f32_dpp v128, v128, v128 row_shr:1 row_mask:0xf bank_mask:0xf bound_ctrl:1
  s_nop 0
  v_add_f32_dpp v130, v130, v130 row_shr:1 row_mask:0xf bank_mask:0xf bound_ctrl:1
  v_add_f32_dpp v128, v128, v128 row_shr:2 row_mask:0xf bank_mask:0xf bound_ctrl:1
  s_nop 0
  v_add_f32_dpp v130, v130, v130 row_shr:2 row_mask:0xf bank_mask:0xf bound_ctrl:1
  v_add_f32_dpp v128, v128, v128 row_shr:4 row_mask:0xf bank_mask:0xf bound_ctrl:1
  s_nop 0
  v_add_f32_dpp v130, v130, v130 row_shr:4 row_mask:0xf bank_mask:0xf bound_ctrl:1
  v_add_f32_dpp v128, v128, v128 row_shr:8 row_mask:0xf bank_mask:0xf bound_ctrl:1
  s_nop 0
  v_add_f32_dpp v130, v130, v130 row_shr:8 row_mask:0xf bank_mask:0xf bound_ctrl:1
  v_add_f32_dpp v128, v128, v128 row_bcast:15 row_mask:0xa bank_mask:0xf
  s_nop 0
  v_add_f32_dpp v130, v130, v130 row_bcast:15 row_mask:0xa bank_mask:0xf
  v_add_f32_dpp v128, v128, v128 row_bcast:31 row_mask:0xc bank_mask:0xf
  s_nop 0
  v_add_f32_dpp v130, v130, v130 row_bcast:31 row_mask:0xc bank_mask:0xf
  v_readlane_b32 s63, v128, 63
  v_readlane_b32 s64, v130, 63
  v_mov_b32 v132, 0x3acccccd
  v_mul_f32 v128, s63, v132
  v_mul_f32 v130, s64, v132
  v_fma_f32 v130, -v128, v128, v130
  v_max_f32 v130, 0, v130
  v_cvt_pk_bf16_f32 v130, v130, v130
  v_and_b32 v130, s60, v130
  v_add_f32 v130, 0x3727c5ac, v130
  v_cvt_pk_bf16_f32 v130, v130, v130
  v_and_b32 v130, s60, v130
  v_sqrt_f32 v130, v130
  v_cvt_pk_bf16_f32 v128, -v128, -v128
  v_cvt_pk_bf16_f32 v130, v130, v130
  v_and_b32 v130, s60, v130
  v_rcp_f32 v130, v130
  v_and_b32 v129, s60, v128
  v_lshlrev_b32 v128, 16, v128
  v_mov_b32 v131, v130
  v_add_f32 v202, v192, v128
  v_add_f32 v203, v193, v129
  v_add_f32 v204, v194, v128
  v_add_f32 v205, v195, v129
  v_add_f32 v206, v196, v128
  v_add_f32 v207, v197, v129
  v_add_f32 v208, v198, v128
  v_add_f32 v209, v199, v129
  v_add_f32 v210, v200, v128
  v_add_f32 v211, v201, v129
  v_cvt_pk_bf16_f32 v136, v202, v203
  v_cvt_pk_bf16_f32 v137, v204, v205
  v_cvt_pk_bf16_f32 v138, v206, v207
  v_cvt_pk_bf16_f32 v139, v208, v209
  v_cvt_pk_bf16_f32 v140, v210, v211
  v_and_b32 v203, s60, v136
  v_lshlrev_b32 v202, 16, v136
  v_and_b32 v205, s60, v137
  v_lshlrev_b32 v204, 16, v137
  v_and_b32 v207, s60, v138
  v_lshlrev_b32 v206, 16, v138
  v_and_b32 v209, s60, v139
  v_lshlrev_b32 v208, 16, v139
  v_and_b32 v211, s60, v140
  v_lshlrev_b32 v210, 16, v140
  v_mul_f32 v202, v202, v130
  v_mul_f32 v203, v203, v131
  v_mul_f32 v204, v204, v130
  v_mul_f32 v205, v205, v131
  v_mul_f32 v206, v206, v130
  v_mul_f32 v207, v207, v131
  v_mul_f32 v208, v208, v130
  v_mul_f32 v209, v209, v131
  v_mul_f32 v210, v210, v130
  v_mul_f32 v211, v211, v131
  v_cvt_pk_bf16_f32 v136, v202, v203
  v_cvt_pk_bf16_f32 v137, v204, v205
  v_cvt_pk_bf16_f32 v138, v206, v207
  v_cvt_pk_bf16_f32 v139, v208, v209
  v_cvt_pk_bf16_f32 v140, v210, v211
  ds_write_b128 v4, v[136:139] offset:1280
  ds_write_b32 v5, v140 offset:2304
  s_waitcnt vmcnt(0)
  ds_write_b128 v4, v[16:19] offset:10240
  ds_write_b32 v5, v20 offset:11264
  v_and_b32 v193, s60, v16
  v_lshlrev_b32 v192, 16, v16
  v_and_b32 v195, s60, v17
  v_lshlrev_b32 v194, 16, v17
  v_and_b32 v197, s60, v18
  v_lshlrev_b32 v196, 16, v18
  v_and_b32 v199, s60, v19
  v_lshlrev_b32 v198, 16, v19
  v_and_b32 v201, s60, v20
  v_lshlrev_b32 v200, 16, v20
  v_add_f32 v128, v192, v194
  v_add_f32 v129, v193, v195
  v_mul_f32 v130, v192, v192
  v_mul_f32 v131, v193, v193
  v_add_f32 v134, v196, v198
  v_add_f32 v135, v197, v199
  v_fma_f32 v130, v194, v194, v130
  v_fma_f32 v131, v195, v195, v131
  v_add_f32 v128, v128, v200
  v_add_f32 v129, v129, v201
  v_fma_f32 v130, v196, v196, v130
  v_fma_f32 v131, v197, v197, v131
  v_add_f32 v128, v128, v134
  v_add_f32 v129, v129, v135
  v_fma_f32 v130, v198, v198, v130
  v_fma_f32 v131, v199, v199, v131
  v_add_f32 v128, v128, v129
  v_fma_f32 v130, v200, v200, v130
  v_fma_f32 v131, v201, v201, v131
  v_add_f32 v130, v130, v131
  v_add_f32_dpp v128, v128, v128 row_shr:1 row_mask:0xf bank_mask:0xf bound_ctrl:1
  s_nop 0
  v_add_f32_dpp v130, v130, v130 row_shr:1 row_mask:0xf bank_mask:0xf bound_ctrl:1
  v_add_f32_dpp v128, v128, v128 row_shr:2 row_mask:0xf bank_mask:0xf bound_ctrl:1
  s_nop 0
  v_add_f32_dpp v130, v130, v130 row_shr:2 row_mask:0xf bank_mask:0xf bound_ctrl:1
  v_add_f32_dpp v128, v128, v128 row_shr:4 row_mask:0xf bank_mask:0xf bound_ctrl:1
  s_nop 0
  v_add_f32_dpp v130, v130, v130 row_shr:4 row_mask:0xf bank_mask:0xf bound_ctrl:1
  v_add_f32_dpp v128, v128, v128 row_shr:8 row_mask:0xf bank_mask:0xf bound_ctrl:1
  s_nop 0
  v_add_f32_dpp v130, v130, v130 row_shr:8 row_mask:0xf bank_mask:0xf bound_ctrl:1
  v_add_f32_dpp v128, v128, v128 row_bcast:15 row_mask:0xa bank_mask:0xf
  s_nop 0
  v_add_f32_dpp v130, v130, v130 row_bcast:15 row_mask:0xa bank_mask:0xf
  v_add_f32_dpp v128, v128, v128 row_bcast:31 row_mask:0xc bank_mask:0xf
  s_nop 0
  v_add_f32_dpp v130, v130, v130 row_bcast:31 row_mask:0xc bank_mask:0xf
  v_readlane_b32 s63, v128, 63
  v_readlane_b32 s64, v130, 63
  v_mov_b32 v132, 0x3acccccd
  v_mul_f32 v128, s63, v132
  v_mul_f32 v130, s64, v132
  v_fma_f32 v130, -v128, v128, v130
  v_max_f32 v130, 0, v130
  v_cvt_pk_bf16_f32 v130, v130, v130
  v_and_b32 v130, s60, v130
  v_add_f32 v130, 0x3727c5ac, v130
  v_cvt_pk_bf16_f32 v130, v130, v130
  v_and_b32 v130, s60, v130
  v_sqrt_f32 v130, v130
  v_cvt_pk_bf16_f32 v128, -v128, -v128
  v_cvt_pk_bf16_f32 v130, v130, v130
  v_and_b32 v130, s60, v130
  v_rcp_f32 v130, v130
  v_and_b32 v129, s60, v128
  v_lshlrev_b32 v128, 16, v128
  v_mov_b32 v131, v130
  v_add_f32 v202, v192, v128
  v_add_f32 v203, v193, v129
  v_add_f32 v204, v194, v128
  v_add_f32 v205, v195, v129
  v_add_f32 v206, v196, v128
  v_add_f32 v207, v197, v129
  v_add_f32 v208, v198, v128
  v_add_f32 v209, v199, v129
  v_add_f32 v210, v200, v128
  v_add_f32 v211, v201, v129
  v_cvt_pk_bf16_f32 v136, v202, v203
  v_cvt_pk_bf16_f32 v137, v204, v205
  v_cvt_pk_bf16_f32 v138, v206, v207
  v_cvt_pk_bf16_f32 v139, v208, v209
  v_cvt_pk_bf16_f32 v140, v210, v211
  v_and_b32 v203, s60, v136
  v_lshlrev_b32 v202, 16, v136
  v_and_b32 v205, s60, v137
  v_lshlrev_b32 v204, 16, v137
  v_and_b32 v207, s60, v138
  v_lshlrev_b32 v206, 16, v138
  v_and_b32 v209, s60, v139
  v_lshlrev_b32 v208, 16, v139
  v_and_b32 v211, s60, v140
  v_lshlrev_b32 v210, 16, v140
  v_mul_f32 v202, v202, v130
  v_mul_f32 v203, v203, v131
  v_mul_f32 v204, v204, v130
  v_mul_f32 v205, v205, v131
  v_mul_f32 v206, v206, v130
  v_mul_f32 v207, v207, v131
  v_mul_f32 v208, v208, v130
  v_mul_f32 v209, v209, v131
  v_mul_f32 v210, v210, v130
  v_mul_f32 v211, v211, v131
  v_cvt_pk_bf16_f32 v136, v202, v203
  v_cvt_pk_bf16_f32 v137, v204, v205
  v_cvt_pk_bf16_f32 v138, v206, v207
  v_cvt_pk_bf16_f32 v139, v208, v209
  v_cvt_pk_bf16_f32 v140, v210, v211
  ds_write_b128 v4, v[136:139] offset:11520
  ds_write_b32 v5, v140 offset:12544
Lhelp:
  v_lshlrev_b32 v2, 4, v1
  s_mul_i32 s63, s6, 5120
  s_mul_i32 s64, s3, 1280
  s_add_u32 s63, s63, s64
  s_add_u32 s63, s63, 2616320
  v_mov_b32 v48, -1
  v_mov_b32 v49, -1
  v_mov_b32 v50, -1
  v_mov_b32 v51, -1
  buffer_store_dwordx4 v[48:51], v2, s[20:23], s63 offen sc1
  s_mov_b64 exec, 0xffff
  buffer_store_dwordx4 v[48:51], v2, s[20:23], s63 offen offset:1024 sc1
  s_mov_b64 exec, -1
  s_cmp_eq_u32 s88, 0
  s_cbranch_scc1 Lpre2
  v_lshrrev_b32 v10, 2, v0
  v_add_u32 v10, 160, v10
  v_and_b32 v11, 3, v0
  v_lshrrev_b32 v16, 1, v10
  v_mul_u32_u24 v16, 20480, v16
  v_and_b32 v12, 1, v10
  v_lshl_add_u32 v16, v12, 6, v16
  v_lshl_add_u32 v16, v11, 4, v16
  s_lshl_b32 s67, s7, 7
  v_add_u32 v28, s67, v16
  v_mul_u32_u24 v29, 4640, v11
  v_lshl_add_u32 v29, v10, 4, v29
  v_add_u32 v29, 127104, v29
  v_subrev_u32 v10, 256, v0
  v_lshrrev_b32 v10, 2, v10
  v_and_b32 v11, 3, v0
  v_lshrrev_b32 v16, 1, v10
  v_mul_u32_u24 v16, 20480, v16
  v_and_b32 v12, 1, v10
  v_lshl_add_u32 v16, v12, 6, v16
  v_lshl_add_u32 v16, v11, 4, v16
  s_lshl_b32 s67, s7, 7
  v_mul_u32_u24 v17, 4640, v11
  v_lshl_add_u32 v17, v10, 4, v17
  v_add_u32 v17, 127104, v17
  s_add_u32 s68, s67, 655360
  s_add_u32 s69, s67, 1310720
  v_mov_b32 v20, 102544
Lf2:
  s_sleep 1
  ds_read_b128 v[24:27], v20
  s_waitcnt lgkmcnt(0)
  v_min3_u32 v24, v24, v25, v26
  v_min_u32 v24, v24, v27
  v_cmp_eq_u32 vcc, 0, v24
  s_cbranch_vccnz Lf2
  ds_read_b128 v[64:67], v17
  ds_read_b128 v[68:71], v17 offset:1024
  ds_read_b128 v[72:75], v17 offset:2048
  s_waitcnt lgkmcnt(2)
  buffer_store_dwordx4 v[64:67], v16, s[20:23], s67 offen sc1
  s_waitcnt lgkmcnt(1)
  buffer_store_dwordx4 v[68:71], v16, s[20:23], s68 offen sc1
  s_waitcnt lgkmcnt(0)
  s_cmp_ge_u32 s3, 6
  s_cbranch_scc1 Lf2e
  buffer_store_dwordx4 v[72:75], v16, s[20:23], s69 offen sc1
Lf2e:
  s_branch Lyst
Lend:
Lexit:
s_endpgm
.section .rodata,"a"
.p2align 6
.amdhsa_kernel sequential_preLN__ssm_conv_h3__moe_arch_mod__prompt_kernel
  .amdhsa_next_free_vgpr 256
  .amdhsa_next_free_sgpr 96
  .amdhsa_accum_offset 256
  .amdhsa_group_segment_fixed_size 0
  .amdhsa_kernarg_size 112
  .amdhsa_user_sgpr_count 2
  .amdhsa_user_sgpr_kernarg_segment_ptr 1
  .amdhsa_system_sgpr_workgroup_id_x 1
  .amdhsa_float_denorm_mode_32 3
.end_amdhsa_kernel
```
